```python
import torch

def _softmax(x, axis=-1):
    return torch.softmax(x, dim=axis)
def _gelu(x):
    return torch.nn.functional.gelu(x, approximate="tanh")
def _silu(x):
    return torch.nn.functional.silu(x)
def _sigmoid(x):
    return torch.sigmoid(x)
def _layernorm(x, axis=-1, eps=1e-5):
    m = x.mean(dim=axis, keepdim=True)
    v = x.var(dim=axis, keepdim=True, unbiased=False)
    return (x - m) / torch.sqrt(v + eps)
def _scatter_add(tgt, idx, src, axis=0):
    return tgt.clone().index_add_(axis, idx, src)
def _segment_sum(src, seg, n):
    out = torch.zeros((n,) + src.shape[1:], dtype=src.dtype)
    return out.index_add_(0, seg, src)
def _pad(x, pw):
    flat = tuple(v for pair in reversed(pw) for v in pair)
    return torch.nn.functional.pad(x, flat)

kernel_name = 'standalone__low_rank_proj_linformer__decode'

def setup_inputs():

    _w = (lambda a: (lambda t: t.to(torch.bfloat16) if t.is_floating_point() else t)(torch.as_tensor(a)))
    B, H, Sq, Skv, Dh, R = 2, 32, 1, 8192, 128, 64
    return {
        "q": _w((lambda *s: torch.randn(*s, dtype=torch.bfloat16) * 0.8)(B, H, Sq, Dh)),
        "k": _w((lambda *s: torch.randn(*s, dtype=torch.bfloat16) * 0.8)(B, H, Skv, Dh)),
        "v": _w((lambda *s: torch.randn(*s, dtype=torch.bfloat16) * 0.05)(B, H, Skv, Dh)),
        "e_proj": _w((lambda *s: torch.randn(*s, dtype=torch.bfloat16) * 0.8)(R, Skv) * (Skv ** -0.5)),
        "f_proj": _w((lambda *s: torch.randn(*s, dtype=torch.bfloat16) * 0.05)(R, Skv) * (Skv ** -0.5)),
    }

def reference(q, k, v, e_proj, f_proj):
    B, H, Sq, Dh = q.shape
    kp = torch.einsum("rn,bhnd->bhrd", e_proj, k)
    vp = torch.einsum("rn,bhnd->bhrd", f_proj, v)
    scores = torch.einsum("bhqd,bhrd->bhqr", q, kp) * (Dh ** -0.5)
    p = _softmax(scores, axis=-1)
    o = torch.einsum("bhqr,bhrd->bhqd", p, vp)
    return o
```

```asm
; @launch grid=(256,1,1) block=(512,1,1) lds=131072
.amdgcn_target "amdgcn-amd-amdhsa--gfx950"
.text
.globl standalone__low_rank_proj_linformer__decode_kernel
.p2align 8
.type standalone__low_rank_proj_linformer__decode_kernel,@function
standalone__low_rank_proj_linformer__decode_kernel:
    s_cmp_ge_u32 s2, 256
    s_cbranch_scc1 L_exit
    s_lshr_b32 s3, s2, 2
    s_lshr_b32 s4, s2, 1
    s_and_b32 s4, s4, 1
    s_and_b32 s5, s2, 1
    s_load_dwordx4 s[8:11], s[0:1], 8
    s_load_dwordx4 s[12:15], s[0:1], 24
    s_load_dwordx2 s[16:17], s[0:1], 0
    s_load_dwordx4 s[20:23], s[0:1], 40
    s_load_dwordx2 s[24:25], s[0:1], 56
    v_readfirstlane_b32 s6, v0
    v_and_b32 v143, 63, v0
    v_lshlrev_b32 v146, 4, v143
    v_and_b32 v144, 15, v143
    v_lshrrev_b32 v145, 4, v143
    s_lshr_b32 s6, s6, 6
    s_waitcnt lgkmcnt(0)
    s_cmp_eq_u32 s4, 0
    s_cselect_b64 s[8:9], s[8:9], s[10:11]
    s_cselect_b64 s[12:13], s[12:13], s[14:15]
    s_and_b32 s9, s9, 0xffff
    s_mov_b32 s10, 134217728
    s_mov_b32 s11, 0x00020000
    s_and_b32 s13, s13, 0xffff
    s_mov_b32 s14, 1048576
    s_mov_b32 s15, 0x00020000
    s_lshl_b32 s26, s3, 21
    s_lshl_b32 s27, s5, 20
    s_add_u32 s26, s26, s27
    s_lshl_b32 s27, s6, 12
    s_add_u32 s26, s26, s27
    v_lshlrev_b32 v136, 4, v144
    v_lshl_add_u32 v136, v145, 10, v136
    v_add_u32 v136, s26, v136
    s_and_b32 s26, s6, 1
    s_lshl_b32 s26, s26, 3
    s_add_u32 s26, s26, 0
    v_add_u32 v148, s26, v145
    v_xor_b32 v148, v148, v144
    v_lshlrev_b32 v148, 4, v148
    v_lshl_add_u32 v137, v145, 14, v148
    s_lshl_b32 s26, s6, 17
    s_add_u32 s26, s26, 0
    s_lshl_b32 s27, s5, 13
    s_add_u32 s26, s26, s27
    v_add_u32 v137, s26, v137
    s_and_b32 s26, s6, 1
    s_lshl_b32 s26, s26, 3
    s_add_u32 s26, s26, 4
    v_add_u32 v148, s26, v145
    v_xor_b32 v148, v148, v144
    v_lshlrev_b32 v148, 4, v148
    v_lshl_add_u32 v138, v145, 14, v148
    s_lshl_b32 s26, s6, 17
    s_add_u32 s26, s26, 65536
    s_lshl_b32 s27, s5, 13
    s_add_u32 s26, s26, s27
    v_add_u32 v138, s26, v138
    v_and_b32 v149, 1, v145
    v_lshlrev_b32 v149, 3, v149
    v_lshl_add_u32 v149, v144, 8, v149
    s_lshr_b32 s26, s6, 2
    s_lshl_b32 s26, s26, 13
    v_add_u32 v149, s26, v149
    v_lshrrev_b32 v150, 1, v145
    v_add_u32 v148, 0, v150
    v_xor_b32 v148, v148, v144
    v_lshl_add_u32 v128, v148, 4, v149
    v_add_u32 v148, 2, v150
    v_xor_b32 v148, v148, v144
    v_lshl_add_u32 v129, v148, 4, v149
    v_add_u32 v148, 4, v150
    v_xor_b32 v148, v148, v144
    v_lshl_add_u32 v130, v148, 4, v149
    v_add_u32 v148, 6, v150
    v_xor_b32 v148, v148, v144
    v_lshl_add_u32 v131, v148, 4, v149
    v_add_u32 v148, 8, v150
    v_xor_b32 v148, v148, v144
    v_lshl_add_u32 v132, v148, 4, v149
    v_add_u32 v148, 10, v150
    v_xor_b32 v148, v148, v144
    v_lshl_add_u32 v133, v148, 4, v149
    v_add_u32 v148, 12, v150
    v_xor_b32 v148, v148, v144
    v_lshl_add_u32 v134, v148, 4, v149
    v_add_u32 v148, 14, v150
    v_xor_b32 v148, v148, v144
    v_lshl_add_u32 v135, v148, 4, v149
    s_lshl_b32 s26, s6, 12
    s_add_u32 s26, s26, 65536
    v_add_u32 v141, s26, v146
    s_and_b32 s26, s6, 3
    s_lshl_b32 s26, s26, 10
    s_add_u32 s26, s26, 65536
    v_add_u32 v142, s26, v146
    v_mov_b32 v139, 0x05040100
    v_mov_b32 v140, 0x07060302
    s_lshl_b32 s28, s6, 11
    s_mov_b32 s18, 0
    s_lshr_b32 s31, s2, 3
    s_and_b32 s31, s31, 31
    s_lshl_b32 s31, s31, 8
    buffer_load_dwordx4 v[152:155], v137, s[12:15], s31 offen
    buffer_load_dwordx4 v[152:155], v138, s[12:15], s31 offen
    buffer_load_dwordx4 v[16:19], v136, s[8:11], 0 offen offset:0 nt
    buffer_load_dwordx4 v[20:23], v136, s[8:11], 0 offen offset:256 nt
    buffer_load_dwordx4 v[24:27], v136, s[8:11], 0 offen offset:512 nt
    buffer_load_dwordx4 v[28:31], v136, s[8:11], 0 offen offset:768 nt
    v_add_u32 v136, 0x8000, v136
    s_add_u32 m0, s28, 0
    s_nop 0
    buffer_load_dwordx4 v137, s[12:15], s18 offen lds
    s_add_u32 m0, s28, 1024
    s_nop 0
    buffer_load_dwordx4 v138, s[12:15], s18 offen lds
    s_add_u32 s18, s18, 0x100
    buffer_load_dwordx4 v[32:35], v136, s[8:11], 0 offen offset:0 nt
    buffer_load_dwordx4 v[36:39], v136, s[8:11], 0 offen offset:256 nt
    buffer_load_dwordx4 v[40:43], v136, s[8:11], 0 offen offset:512 nt
    buffer_load_dwordx4 v[44:47], v136, s[8:11], 0 offen offset:768 nt
    v_add_u32 v136, 0x8000, v136
    s_add_u32 m0, s28, 16384
    s_nop 0
    buffer_load_dwordx4 v137, s[12:15], s18 offen lds
    s_add_u32 m0, s28, 17408
    s_nop 0
    buffer_load_dwordx4 v138, s[12:15], s18 offen lds
    s_add_u32 s18, s18, 0x100
    v_mov_b32 v0, 0
    v_mov_b32 v1, 0
    v_mov_b32 v2, 0
    v_mov_b32 v3, 0
    v_mov_b32 v4, 0
    v_mov_b32 v5, 0
    v_mov_b32 v6, 0
    v_mov_b32 v7, 0
    v_mov_b32 v8, 0
    v_mov_b32 v9, 0
    v_mov_b32 v10, 0
    v_mov_b32 v11, 0
    v_mov_b32 v12, 0
    v_mov_b32 v13, 0
    v_mov_b32 v14, 0
    v_mov_b32 v15, 0
    s_waitcnt vmcnt(8) lgkmcnt(0)
    s_barrier
    v_perm_b32 v48, v20, v16, v139
    v_perm_b32 v49, v28, v24, v139
    v_perm_b32 v50, v20, v16, v140
    v_perm_b32 v51, v28, v24, v140
    v_perm_b32 v52, v21, v17, v139
    v_perm_b32 v53, v29, v25, v139
    v_perm_b32 v54, v21, v17, v140
    v_perm_b32 v55, v29, v25, v140
    v_perm_b32 v56, v22, v18, v139
    v_perm_b32 v57, v30, v26, v139
    v_perm_b32 v58, v22, v18, v140
    v_perm_b32 v59, v30, v26, v140
    v_perm_b32 v60, v23, v19, v139
    v_perm_b32 v61, v31, v27, v139
    v_perm_b32 v62, v23, v19, v140
    v_perm_b32 v63, v31, v27, v140
    ds_write_b128 v141, v[48:51] offset:0
    ds_write_b128 v141, v[52:55] offset:1024
    ds_write_b128 v141, v[56:59] offset:2048
    ds_write_b128 v141, v[60:63] offset:3072
    buffer_load_dwordx4 v[16:19], v136, s[8:11], 0 offen offset:0 nt
    buffer_load_dwordx4 v[20:23], v136, s[8:11], 0 offen offset:256 nt
    buffer_load_dwordx4 v[24:27], v136, s[8:11], 0 offen offset:512 nt
    buffer_load_dwordx4 v[28:31], v136, s[8:11], 0 offen offset:768 nt
    v_add_u32 v136, 0x8000, v136
    s_add_u32 m0, s28, 32768
    s_nop 0
    buffer_load_dwordx4 v137, s[12:15], s18 offen lds
    s_add_u32 m0, s28, 33792
    s_nop 0
    buffer_load_dwordx4 v138, s[12:15], s18 offen lds
    s_add_u32 s18, s18, 0x100
    s_waitcnt vmcnt(8) lgkmcnt(0)
    s_barrier
    ds_read_b64 v[64:65], v128 offset:0
    ds_read_b64 v[66:67], v128 offset:4096
    ds_read_b128 v[96:99], v142 offset:0
    ds_read_b64 v[68:69], v129 offset:0
    ds_read_b64 v[70:71], v129 offset:4096
    ds_read_b128 v[100:103], v142 offset:4096
    ds_read_b64 v[72:73], v130 offset:0
    ds_read_b64 v[74:75], v130 offset:4096
    ds_read_b128 v[104:107], v142 offset:8192
    ds_read_b64 v[76:77], v131 offset:0
    ds_read_b64 v[78:79], v131 offset:4096
    ds_read_b128 v[108:111], v142 offset:12288
    ds_read_b64 v[80:81], v132 offset:0
    ds_read_b64 v[82:83], v132 offset:4096
    ds_read_b128 v[112:115], v142 offset:16384
    ds_read_b64 v[84:85], v133 offset:0
    ds_read_b64 v[86:87], v133 offset:4096
    ds_read_b128 v[116:119], v142 offset:20480
    ds_read_b64 v[88:89], v134 offset:0
    ds_read_b64 v[90:91], v134 offset:4096
    ds_read_b128 v[120:123], v142 offset:24576
    ds_read_b64 v[92:93], v135 offset:0
    ds_read_b64 v[94:95], v135 offset:4096
    ds_read_b128 v[124:127], v142 offset:28672
    v_perm_b32 v48, v36, v32, v139
    v_perm_b32 v49, v44, v40, v139
    v_perm_b32 v50, v36, v32, v140
    v_perm_b32 v51, v44, v40, v140
    v_perm_b32 v52, v37, v33, v139
    v_perm_b32 v53, v45, v41, v139
    v_perm_b32 v54, v37, v33, v140
    v_perm_b32 v55, v45, v41, v140
    v_perm_b32 v56, v38, v34, v139
    v_perm_b32 v57, v46, v42, v139
    v_perm_b32 v58, v38, v34, v140
    v_perm_b32 v59, v46, v42, v140
    v_perm_b32 v60, v39, v35, v139
    v_perm_b32 v61, v47, v43, v139
    v_perm_b32 v62, v39, v35, v140
    v_perm_b32 v63, v47, v43, v140
    ds_write_b128 v141, v[48:51] offset:32768
    ds_write_b128 v141, v[52:55] offset:33792
    ds_write_b128 v141, v[56:59] offset:34816
    ds_write_b128 v141, v[60:63] offset:35840
    buffer_load_dwordx4 v[32:35], v136, s[8:11], 0 offen offset:0 nt
    buffer_load_dwordx4 v[36:39], v136, s[8:11], 0 offen offset:256 nt
    buffer_load_dwordx4 v[40:43], v136, s[8:11], 0 offen offset:512 nt
    buffer_load_dwordx4 v[44:47], v136, s[8:11], 0 offen offset:768 nt
    v_add_u32 v136, 0x8000, v136
    s_add_u32 m0, s28, 49152
    s_nop 0
    buffer_load_dwordx4 v137, s[12:15], s18 offen lds
    s_add_u32 m0, s28, 50176
    s_nop 0
    buffer_load_dwordx4 v138, s[12:15], s18 offen lds
    s_add_u32 s18, s18, 0x100
    s_waitcnt lgkmcnt(4)
    v_mfma_f32_16x16x16_bf16 v[0:3], v[64:65], v[96:97], v[0:3]
    v_mfma_f32_16x16x16_bf16 v[4:7], v[64:65], v[98:99], v[4:7]
    v_mfma_f32_16x16x16_bf16 v[8:11], v[66:67], v[96:97], v[8:11]
    v_mfma_f32_16x16x16_bf16 v[12:15], v[66:67], v[98:99], v[12:15]
    v_mfma_f32_16x16x16_bf16 v[0:3], v[68:69], v[100:101], v[0:3]
    v_mfma_f32_16x16x16_bf16 v[4:7], v[68:69], v[102:103], v[4:7]
    v_mfma_f32_16x16x16_bf16 v[8:11], v[70:71], v[100:101], v[8:11]
    v_mfma_f32_16x16x16_bf16 v[12:15], v[70:71], v[102:103], v[12:15]
    v_mfma_f32_16x16x16_bf16 v[0:3], v[72:73], v[104:105], v[0:3]
    v_mfma_f32_16x16x16_bf16 v[4:7], v[72:73], v[106:107], v[4:7]
    v_mfma_f32_16x16x16_bf16 v[8:11], v[74:75], v[104:105], v[8:11]
    v_mfma_f32_16x16x16_bf16 v[12:15], v[74:75], v[106:107], v[12:15]
    v_mfma_f32_16x16x16_bf16 v[0:3], v[76:77], v[108:109], v[0:3]
    v_mfma_f32_16x16x16_bf16 v[4:7], v[76:77], v[110:111], v[4:7]
    v_mfma_f32_16x16x16_bf16 v[8:11], v[78:79], v[108:109], v[8:11]
    v_mfma_f32_16x16x16_bf16 v[12:15], v[78:79], v[110:111], v[12:15]
    v_mfma_f32_16x16x16_bf16 v[0:3], v[80:81], v[112:113], v[0:3]
    v_mfma_f32_16x16x16_bf16 v[4:7], v[80:81], v[114:115], v[4:7]
    v_mfma_f32_16x16x16_bf16 v[8:11], v[82:83], v[112:113], v[8:11]
    v_mfma_f32_16x16x16_bf16 v[12:15], v[82:83], v[114:115], v[12:15]
    v_mfma_f32_16x16x16_bf16 v[0:3], v[84:85], v[116:117], v[0:3]
    v_mfma_f32_16x16x16_bf16 v[4:7], v[84:85], v[118:119], v[4:7]
    v_mfma_f32_16x16x16_bf16 v[8:11], v[86:87], v[116:117], v[8:11]
    v_mfma_f32_16x16x16_bf16 v[12:15], v[86:87], v[118:119], v[12:15]
    v_mfma_f32_16x16x16_bf16 v[0:3], v[88:89], v[120:121], v[0:3]
    v_mfma_f32_16x16x16_bf16 v[4:7], v[88:89], v[122:123], v[4:7]
    v_mfma_f32_16x16x16_bf16 v[8:11], v[90:91], v[120:121], v[8:11]
    v_mfma_f32_16x16x16_bf16 v[12:15], v[90:91], v[122:123], v[12:15]
    v_mfma_f32_16x16x16_bf16 v[0:3], v[92:93], v[124:125], v[0:3]
    v_mfma_f32_16x16x16_bf16 v[4:7], v[92:93], v[126:127], v[4:7]
    v_mfma_f32_16x16x16_bf16 v[8:11], v[94:95], v[124:125], v[8:11]
    v_mfma_f32_16x16x16_bf16 v[12:15], v[94:95], v[126:127], v[12:15]
    s_waitcnt vmcnt(8) lgkmcnt(0)
    s_barrier
    ds_read_b64 v[64:65], v128 offset:16384
    ds_read_b64 v[66:67], v128 offset:20480
    ds_read_b128 v[96:99], v142 offset:32768
    ds_read_b64 v[68:69], v129 offset:16384
    ds_read_b64 v[70:71], v129 offset:20480
    ds_read_b128 v[100:103], v142 offset:36864
    ds_read_b64 v[72:73], v130 offset:16384
    ds_read_b64 v[74:75], v130 offset:20480
    ds_read_b128 v[104:107], v142 offset:40960
    ds_read_b64 v[76:77], v131 offset:16384
    ds_read_b64 v[78:79], v131 offset:20480
    ds_read_b128 v[108:111], v142 offset:45056
    ds_read_b64 v[80:81], v132 offset:16384
    ds_read_b64 v[82:83], v132 offset:20480
    ds_read_b128 v[112:115], v142 offset:49152
    ds_read_b64 v[84:85], v133 offset:16384
    ds_read_b64 v[86:87], v133 offset:20480
    ds_read_b128 v[116:119], v142 offset:53248
    ds_read_b64 v[88:89], v134 offset:16384
    ds_read_b64 v[90:91], v134 offset:20480
    ds_read_b128 v[120:123], v142 offset:57344
    ds_read_b64 v[92:93], v135 offset:16384
    ds_read_b64 v[94:95], v135 offset:20480
    ds_read_b128 v[124:127], v142 offset:61440
    v_perm_b32 v48, v20, v16, v139
    v_perm_b32 v49, v28, v24, v139
    v_perm_b32 v50, v20, v16, v140
    v_perm_b32 v51, v28, v24, v140
    v_perm_b32 v52, v21, v17, v139
    v_perm_b32 v53, v29, v25, v139
    v_perm_b32 v54, v21, v17, v140
    v_perm_b32 v55, v29, v25, v140
    v_perm_b32 v56, v22, v18, v139
    v_perm_b32 v57, v30, v26, v139
    v_perm_b32 v58, v22, v18, v140
    v_perm_b32 v59, v30, v26, v140
    v_perm_b32 v60, v23, v19, v139
    v_perm_b32 v61, v31, v27, v139
    v_perm_b32 v62, v23, v19, v140
    v_perm_b32 v63, v31, v27, v140
    ds_write_b128 v141, v[48:51] offset:0
    ds_write_b128 v141, v[52:55] offset:1024
    ds_write_b128 v141, v[56:59] offset:2048
    ds_write_b128 v141, v[60:63] offset:3072
    buffer_load_dwordx4 v[16:19], v136, s[8:11], 0 offen offset:0 nt
    buffer_load_dwordx4 v[20:23], v136, s[8:11], 0 offen offset:256 nt
    buffer_load_dwordx4 v[24:27], v136, s[8:11], 0 offen offset:512 nt
    buffer_load_dwordx4 v[28:31], v136, s[8:11], 0 offen offset:768 nt
    v_add_u32 v136, 0x8000, v136
    s_add_u32 m0, s28, 0
    s_nop 0
    buffer_load_dwordx4 v137, s[12:15], s18 offen lds
    s_add_u32 m0, s28, 1024
    s_nop 0
    buffer_load_dwordx4 v138, s[12:15], s18 offen lds
    s_add_u32 s18, s18, 0x100
    s_waitcnt lgkmcnt(4)
    v_mfma_f32_16x16x16_bf16 v[0:3], v[64:65], v[96:97], v[0:3]
    v_mfma_f32_16x16x16_bf16 v[4:7], v[64:65], v[98:99], v[4:7]
    v_mfma_f32_16x16x16_bf16 v[8:11], v[66:67], v[96:97], v[8:11]
    v_mfma_f32_16x16x16_bf16 v[12:15], v[66:67], v[98:99], v[12:15]
    v_mfma_f32_16x16x16_bf16 v[0:3], v[68:69], v[100:101], v[0:3]
    v_mfma_f32_16x16x16_bf16 v[4:7], v[68:69], v[102:103], v[4:7]
    v_mfma_f32_16x16x16_bf16 v[8:11], v[70:71], v[100:101], v[8:11]
    v_mfma_f32_16x16x16_bf16 v[12:15], v[70:71], v[102:103], v[12:15]
    v_mfma_f32_16x16x16_bf16 v[0:3], v[72:73], v[104:105], v[0:3]
    v_mfma_f32_16x16x16_bf16 v[4:7], v[72:73], v[106:107], v[4:7]
    v_mfma_f32_16x16x16_bf16 v[8:11], v[74:75], v[104:105], v[8:11]
    v_mfma_f32_16x16x16_bf16 v[12:15], v[74:75], v[106:107], v[12:15]
    v_mfma_f32_16x16x16_bf16 v[0:3], v[76:77], v[108:109], v[0:3]
    v_mfma_f32_16x16x16_bf16 v[4:7], v[76:77], v[110:111], v[4:7]
    v_mfma_f32_16x16x16_bf16 v[8:11], v[78:79], v[108:109], v[8:11]
    v_mfma_f32_16x16x16_bf16 v[12:15], v[78:79], v[110:111], v[12:15]
    v_mfma_f32_16x16x16_bf16 v[0:3], v[80:81], v[112:113], v[0:3]
    v_mfma_f32_16x16x16_bf16 v[4:7], v[80:81], v[114:115], v[4:7]
    v_mfma_f32_16x16x16_bf16 v[8:11], v[82:83], v[112:113], v[8:11]
    v_mfma_f32_16x16x16_bf16 v[12:15], v[82:83], v[114:115], v[12:15]
    v_mfma_f32_16x16x16_bf16 v[0:3], v[84:85], v[116:117], v[0:3]
    v_mfma_f32_16x16x16_bf16 v[4:7], v[84:85], v[118:119], v[4:7]
    v_mfma_f32_16x16x16_bf16 v[8:11], v[86:87], v[116:117], v[8:11]
    v_mfma_f32_16x16x16_bf16 v[12:15], v[86:87], v[118:119], v[12:15]
    v_mfma_f32_16x16x16_bf16 v[0:3], v[88:89], v[120:121], v[0:3]
    v_mfma_f32_16x16x16_bf16 v[4:7], v[88:89], v[122:123], v[4:7]
    v_mfma_f32_16x16x16_bf16 v[8:11], v[90:91], v[120:121], v[8:11]
    v_mfma_f32_16x16x16_bf16 v[12:15], v[90:91], v[122:123], v[12:15]
    v_mfma_f32_16x16x16_bf16 v[0:3], v[92:93], v[124:125], v[0:3]
    v_mfma_f32_16x16x16_bf16 v[4:7], v[92:93], v[126:127], v[4:7]
    v_mfma_f32_16x16x16_bf16 v[8:11], v[94:95], v[124:125], v[8:11]
    v_mfma_f32_16x16x16_bf16 v[12:15], v[94:95], v[126:127], v[12:15]
    s_waitcnt vmcnt(8) lgkmcnt(0)
    s_barrier
    ds_read_b64 v[64:65], v128 offset:32768
    ds_read_b64 v[66:67], v128 offset:36864
    ds_read_b128 v[96:99], v142 offset:0
    ds_read_b64 v[68:69], v129 offset:32768
    ds_read_b64 v[70:71], v129 offset:36864
    ds_read_b128 v[100:103], v142 offset:4096
    ds_read_b64 v[72:73], v130 offset:32768
    ds_read_b64 v[74:75], v130 offset:36864
    ds_read_b128 v[104:107], v142 offset:8192
    ds_read_b64 v[76:77], v131 offset:32768
    ds_read_b64 v[78:79], v131 offset:36864
    ds_read_b128 v[108:111], v142 offset:12288
    ds_read_b64 v[80:81], v132 offset:32768
    ds_read_b64 v[82:83], v132 offset:36864
    ds_read_b128 v[112:115], v142 offset:16384
    ds_read_b64 v[84:85], v133 offset:32768
    ds_read_b64 v[86:87], v133 offset:36864
    ds_read_b128 v[116:119], v142 offset:20480
    ds_read_b64 v[88:89], v134 offset:32768
    ds_read_b64 v[90:91], v134 offset:36864
    ds_read_b128 v[120:123], v142 offset:24576
    ds_read_b64 v[92:93], v135 offset:32768
    ds_read_b64 v[94:95], v135 offset:36864
    ds_read_b128 v[124:127], v142 offset:28672
    v_perm_b32 v48, v36, v32, v139
    v_perm_b32 v49, v44, v40, v139
    v_perm_b32 v50, v36, v32, v140
    v_perm_b32 v51, v44, v40, v140
    v_perm_b32 v52, v37, v33, v139
    v_perm_b32 v53, v45, v41, v139
    v_perm_b32 v54, v37, v33, v140
    v_perm_b32 v55, v45, v41, v140
    v_perm_b32 v56, v38, v34, v139
    v_perm_b32 v57, v46, v42, v139
    v_perm_b32 v58, v38, v34, v140
    v_perm_b32 v59, v46, v42, v140
    v_perm_b32 v60, v39, v35, v139
    v_perm_b32 v61, v47, v43, v139
    v_perm_b32 v62, v39, v35, v140
    v_perm_b32 v63, v47, v43, v140
    ds_write_b128 v141, v[48:51] offset:32768
    ds_write_b128 v141, v[52:55] offset:33792
    ds_write_b128 v141, v[56:59] offset:34816
    ds_write_b128 v141, v[60:63] offset:35840
    buffer_load_dwordx4 v[32:35], v136, s[8:11], 0 offen offset:0 nt
    buffer_load_dwordx4 v[36:39], v136, s[8:11], 0 offen offset:256 nt
    buffer_load_dwordx4 v[40:43], v136, s[8:11], 0 offen offset:512 nt
    buffer_load_dwordx4 v[44:47], v136, s[8:11], 0 offen offset:768 nt
    v_add_u32 v136, 0x8000, v136
    s_add_u32 m0, s28, 16384
    s_nop 0
    buffer_load_dwordx4 v137, s[12:15], s18 offen lds
    s_add_u32 m0, s28, 17408
    s_nop 0
    buffer_load_dwordx4 v138, s[12:15], s18 offen lds
    s_add_u32 s18, s18, 0x100
    s_waitcnt lgkmcnt(4)
    v_mfma_f32_16x16x16_bf16 v[0:3], v[64:65], v[96:97], v[0:3]
    v_mfma_f32_16x16x16_bf16 v[4:7], v[64:65], v[98:99], v[4:7]
    v_mfma_f32_16x16x16_bf16 v[8:11], v[66:67], v[96:97], v[8:11]
    v_mfma_f32_16x16x16_bf16 v[12:15], v[66:67], v[98:99], v[12:15]
    v_mfma_f32_16x16x16_bf16 v[0:3], v[68:69], v[100:101], v[0:3]
    v_mfma_f32_16x16x16_bf16 v[4:7], v[68:69], v[102:103], v[4:7]
    v_mfma_f32_16x16x16_bf16 v[8:11], v[70:71], v[100:101], v[8:11]
    v_mfma_f32_16x16x16_bf16 v[12:15], v[70:71], v[102:103], v[12:15]
    v_mfma_f32_16x16x16_bf16 v[0:3], v[72:73], v[104:105], v[0:3]
    v_mfma_f32_16x16x16_bf16 v[4:7], v[72:73], v[106:107], v[4:7]
    v_mfma_f32_16x16x16_bf16 v[8:11], v[74:75], v[104:105], v[8:11]
    v_mfma_f32_16x16x16_bf16 v[12:15], v[74:75], v[106:107], v[12:15]
    v_mfma_f32_16x16x16_bf16 v[0:3], v[76:77], v[108:109], v[0:3]
    v_mfma_f32_16x16x16_bf16 v[4:7], v[76:77], v[110:111], v[4:7]
    v_mfma_f32_16x16x16_bf16 v[8:11], v[78:79], v[108:109], v[8:11]
    v_mfma_f32_16x16x16_bf16 v[12:15], v[78:79], v[110:111], v[12:15]
    v_mfma_f32_16x16x16_bf16 v[0:3], v[80:81], v[112:113], v[0:3]
    v_mfma_f32_16x16x16_bf16 v[4:7], v[80:81], v[114:115], v[4:7]
    v_mfma_f32_16x16x16_bf16 v[8:11], v[82:83], v[112:113], v[8:11]
    v_mfma_f32_16x16x16_bf16 v[12:15], v[82:83], v[114:115], v[12:15]
    v_mfma_f32_16x16x16_bf16 v[0:3], v[84:85], v[116:117], v[0:3]
    v_mfma_f32_16x16x16_bf16 v[4:7], v[84:85], v[118:119], v[4:7]
    v_mfma_f32_16x16x16_bf16 v[8:11], v[86:87], v[116:117], v[8:11]
    v_mfma_f32_16x16x16_bf16 v[12:15], v[86:87], v[118:119], v[12:15]
    v_mfma_f32_16x16x16_bf16 v[0:3], v[88:89], v[120:121], v[0:3]
    v_mfma_f32_16x16x16_bf16 v[4:7], v[88:89], v[122:123], v[4:7]
    v_mfma_f32_16x16x16_bf16 v[8:11], v[90:91], v[120:121], v[8:11]
    v_mfma_f32_16x16x16_bf16 v[12:15], v[90:91], v[122:123], v[12:15]
    v_mfma_f32_16x16x16_bf16 v[0:3], v[92:93], v[124:125], v[0:3]
    v_mfma_f32_16x16x16_bf16 v[4:7], v[92:93], v[126:127], v[4:7]
    v_mfma_f32_16x16x16_bf16 v[8:11], v[94:95], v[124:125], v[8:11]
    v_mfma_f32_16x16x16_bf16 v[12:15], v[94:95], v[126:127], v[12:15]
    s_mov_b32 s19, 6
L_loop:
    s_waitcnt vmcnt(8) lgkmcnt(0)
    s_barrier
    ds_read_b64 v[64:65], v128 offset:49152
    ds_read_b64 v[66:67], v128 offset:53248
    ds_read_b128 v[96:99], v142 offset:32768
    ds_read_b64 v[68:69], v129 offset:49152
    ds_read_b64 v[70:71], v129 offset:53248
    ds_read_b128 v[100:103], v142 offset:36864
    ds_read_b64 v[72:73], v130 offset:49152
    ds_read_b64 v[74:75], v130 offset:53248
    ds_read_b128 v[104:107], v142 offset:40960
    ds_read_b64 v[76:77], v131 offset:49152
    ds_read_b64 v[78:79], v131 offset:53248
    ds_read_b128 v[108:111], v142 offset:45056
    ds_read_b64 v[80:81], v132 offset:49152
    ds_read_b64 v[82:83], v132 offset:53248
    ds_read_b128 v[112:115], v142 offset:49152
    ds_read_b64 v[84:85], v133 offset:49152
    ds_read_b64 v[86:87], v133 offset:53248
    ds_read_b128 v[116:119], v142 offset:53248
    ds_read_b64 v[88:89], v134 offset:49152
    ds_read_b64 v[90:91], v134 offset:53248
    ds_read_b128 v[120:123], v142 offset:57344
    ds_read_b64 v[92:93], v135 offset:49152
    ds_read_b64 v[94:95], v135 offset:53248
    ds_read_b128 v[124:127], v142 offset:61440
    v_perm_b32 v48, v20, v16, v139
    v_perm_b32 v49, v28, v24, v139
    v_perm_b32 v50, v20, v16, v140
    v_perm_b32 v51, v28, v24, v140
    v_perm_b32 v52, v21, v17, v139
    v_perm_b32 v53, v29, v25, v139
    v_perm_b32 v54, v21, v17, v140
    v_perm_b32 v55, v29, v25, v140
    v_perm_b32 v56, v22, v18, v139
    v_perm_b32 v57, v30, v26, v139
    v_perm_b32 v58, v22, v18, v140
    v_perm_b32 v59, v30, v26, v140
    v_perm_b32 v60, v23, v19, v139
    v_perm_b32 v61, v31, v27, v139
    v_perm_b32 v62, v23, v19, v140
    v_perm_b32 v63, v31, v27, v140
    ds_write_b128 v141, v[48:51] offset:0
    ds_write_b128 v141, v[52:55] offset:1024
    ds_write_b128 v141, v[56:59] offset:2048
    ds_write_b128 v141, v[60:63] offset:3072
    buffer_load_dwordx4 v[16:19], v136, s[8:11], 0 offen offset:0 nt
    buffer_load_dwordx4 v[20:23], v136, s[8:11], 0 offen offset:256 nt
    buffer_load_dwordx4 v[24:27], v136, s[8:11], 0 offen offset:512 nt
    buffer_load_dwordx4 v[28:31], v136, s[8:11], 0 offen offset:768 nt
    v_add_u32 v136, 0x8000, v136
    s_add_u32 m0, s28, 32768
    s_nop 0
    buffer_load_dwordx4 v137, s[12:15], s18 offen lds
    s_add_u32 m0, s28, 33792
    s_nop 0
    buffer_load_dwordx4 v138, s[12:15], s18 offen lds
    s_add_u32 s18, s18, 0x100
    s_waitcnt lgkmcnt(4)
    v_mfma_f32_16x16x16_bf16 v[0:3], v[64:65], v[96:97], v[0:3]
    v_mfma_f32_16x16x16_bf16 v[4:7], v[64:65], v[98:99], v[4:7]
    v_mfma_f32_16x16x16_bf16 v[8:11], v[66:67], v[96:97], v[8:11]
    v_mfma_f32_16x16x16_bf16 v[12:15], v[66:67], v[98:99], v[12:15]
    v_mfma_f32_16x16x16_bf16 v[0:3], v[68:69], v[100:101], v[0:3]
    v_mfma_f32_16x16x16_bf16 v[4:7], v[68:69], v[102:103], v[4:7]
    v_mfma_f32_16x16x16_bf16 v[8:11], v[70:71], v[100:101], v[8:11]
    v_mfma_f32_16x16x16_bf16 v[12:15], v[70:71], v[102:103], v[12:15]
    v_mfma_f32_16x16x16_bf16 v[0:3], v[72:73], v[104:105], v[0:3]
    v_mfma_f32_16x16x16_bf16 v[4:7], v[72:73], v[106:107], v[4:7]
    v_mfma_f32_16x16x16_bf16 v[8:11], v[74:75], v[104:105], v[8:11]
    v_mfma_f32_16x16x16_bf16 v[12:15], v[74:75], v[106:107], v[12:15]
    v_mfma_f32_16x16x16_bf16 v[0:3], v[76:77], v[108:109], v[0:3]
    v_mfma_f32_16x16x16_bf16 v[4:7], v[76:77], v[110:111], v[4:7]
    v_mfma_f32_16x16x16_bf16 v[8:11], v[78:79], v[108:109], v[8:11]
    v_mfma_f32_16x16x16_bf16 v[12:15], v[78:79], v[110:111], v[12:15]
    v_mfma_f32_16x16x16_bf16 v[0:3], v[80:81], v[112:113], v[0:3]
    v_mfma_f32_16x16x16_bf16 v[4:7], v[80:81], v[114:115], v[4:7]
    v_mfma_f32_16x16x16_bf16 v[8:11], v[82:83], v[112:113], v[8:11]
    v_mfma_f32_16x16x16_bf16 v[12:15], v[82:83], v[114:115], v[12:15]
    v_mfma_f32_16x16x16_bf16 v[0:3], v[84:85], v[116:117], v[0:3]
    v_mfma_f32_16x16x16_bf16 v[4:7], v[84:85], v[118:119], v[4:7]
    v_mfma_f32_16x16x16_bf16 v[8:11], v[86:87], v[116:117], v[8:11]
    v_mfma_f32_16x16x16_bf16 v[12:15], v[86:87], v[118:119], v[12:15]
    v_mfma_f32_16x16x16_bf16 v[0:3], v[88:89], v[120:121], v[0:3]
    v_mfma_f32_16x16x16_bf16 v[4:7], v[88:89], v[122:123], v[4:7]
    v_mfma_f32_16x16x16_bf16 v[8:11], v[90:91], v[120:121], v[8:11]
    v_mfma_f32_16x16x16_bf16 v[12:15], v[90:91], v[122:123], v[12:15]
    v_mfma_f32_16x16x16_bf16 v[0:3], v[92:93], v[124:125], v[0:3]
    v_mfma_f32_16x16x16_bf16 v[4:7], v[92:93], v[126:127], v[4:7]
    v_mfma_f32_16x16x16_bf16 v[8:11], v[94:95], v[124:125], v[8:11]
    v_mfma_f32_16x16x16_bf16 v[12:15], v[94:95], v[126:127], v[12:15]
    s_waitcnt vmcnt(8) lgkmcnt(0)
    s_barrier
    ds_read_b64 v[64:65], v128 offset:0
    ds_read_b64 v[66:67], v128 offset:4096
    ds_read_b128 v[96:99], v142 offset:0
    ds_read_b64 v[68:69], v129 offset:0
    ds_read_b64 v[70:71], v129 offset:4096
    ds_read_b128 v[100:103], v142 offset:4096
    ds_read_b64 v[72:73], v130 offset:0
    ds_read_b64 v[74:75], v130 offset:4096
    ds_read_b128 v[104:107], v142 offset:8192
    ds_read_b64 v[76:77], v131 offset:0
    ds_read_b64 v[78:79], v131 offset:4096
    ds_read_b128 v[108:111], v142 offset:12288
    ds_read_b64 v[80:81], v132 offset:0
    ds_read_b64 v[82:83], v132 offset:4096
    ds_read_b128 v[112:115], v142 offset:16384
    ds_read_b64 v[84:85], v133 offset:0
    ds_read_b64 v[86:87], v133 offset:4096
    ds_read_b128 v[116:119], v142 offset:20480
    ds_read_b64 v[88:89], v134 offset:0
    ds_read_b64 v[90:91], v134 offset:4096
    ds_read_b128 v[120:123], v142 offset:24576
    ds_read_b64 v[92:93], v135 offset:0
    ds_read_b64 v[94:95], v135 offset:4096
    ds_read_b128 v[124:127], v142 offset:28672
    v_perm_b32 v48, v36, v32, v139
    v_perm_b32 v49, v44, v40, v139
    v_perm_b32 v50, v36, v32, v140
    v_perm_b32 v51, v44, v40, v140
    v_perm_b32 v52, v37, v33, v139
    v_perm_b32 v53, v45, v41, v139
    v_perm_b32 v54, v37, v33, v140
    v_perm_b32 v55, v45, v41, v140
    v_perm_b32 v56, v38, v34, v139
    v_perm_b32 v57, v46, v42, v139
    v_perm_b32 v58, v38, v34, v140
    v_perm_b32 v59, v46, v42, v140
    v_perm_b32 v60, v39, v35, v139
    v_perm_b32 v61, v47, v43, v139
    v_perm_b32 v62, v39, v35, v140
    v_perm_b32 v63, v47, v43, v140
    ds_write_b128 v141, v[48:51] offset:32768
    ds_write_b128 v141, v[52:55] offset:33792
    ds_write_b128 v141, v[56:59] offset:34816
    ds_write_b128 v141, v[60:63] offset:35840
    buffer_load_dwordx4 v[32:35], v136, s[8:11], 0 offen offset:0 nt
    buffer_load_dwordx4 v[36:39], v136, s[8:11], 0 offen offset:256 nt
    buffer_load_dwordx4 v[40:43], v136, s[8:11], 0 offen offset:512 nt
    buffer_load_dwordx4 v[44:47], v136, s[8:11], 0 offen offset:768 nt
    v_add_u32 v136, 0x8000, v136
    s_add_u32 m0, s28, 49152
    s_nop 0
    buffer_load_dwordx4 v137, s[12:15], s18 offen lds
    s_add_u32 m0, s28, 50176
    s_nop 0
    buffer_load_dwordx4 v138, s[12:15], s18 offen lds
    s_add_u32 s18, s18, 0x100
    s_waitcnt lgkmcnt(4)
    v_mfma_f32_16x16x16_bf16 v[0:3], v[64:65], v[96:97], v[0:3]
    v_mfma_f32_16x16x16_bf16 v[4:7], v[64:65], v[98:99], v[4:7]
    v_mfma_f32_16x16x16_bf16 v[8:11], v[66:67], v[96:97], v[8:11]
    v_mfma_f32_16x16x16_bf16 v[12:15], v[66:67], v[98:99], v[12:15]
    v_mfma_f32_16x16x16_bf16 v[0:3], v[68:69], v[100:101], v[0:3]
    v_mfma_f32_16x16x16_bf16 v[4:7], v[68:69], v[102:103], v[4:7]
    v_mfma_f32_16x16x16_bf16 v[8:11], v[70:71], v[100:101], v[8:11]
    v_mfma_f32_16x16x16_bf16 v[12:15], v[70:71], v[102:103], v[12:15]
    v_mfma_f32_16x16x16_bf16 v[0:3], v[72:73], v[104:105], v[0:3]
    v_mfma_f32_16x16x16_bf16 v[4:7], v[72:73], v[106:107], v[4:7]
    v_mfma_f32_16x16x16_bf16 v[8:11], v[74:75], v[104:105], v[8:11]
    v_mfma_f32_16x16x16_bf16 v[12:15], v[74:75], v[106:107], v[12:15]
    v_mfma_f32_16x16x16_bf16 v[0:3], v[76:77], v[108:109], v[0:3]
    v_mfma_f32_16x16x16_bf16 v[4:7], v[76:77], v[110:111], v[4:7]
    v_mfma_f32_16x16x16_bf16 v[8:11], v[78:79], v[108:109], v[8:11]
    v_mfma_f32_16x16x16_bf16 v[12:15], v[78:79], v[110:111], v[12:15]
    v_mfma_f32_16x16x16_bf16 v[0:3], v[80:81], v[112:113], v[0:3]
    v_mfma_f32_16x16x16_bf16 v[4:7], v[80:81], v[114:115], v[4:7]
    v_mfma_f32_16x16x16_bf16 v[8:11], v[82:83], v[112:113], v[8:11]
    v_mfma_f32_16x16x16_bf16 v[12:15], v[82:83], v[114:115], v[12:15]
    v_mfma_f32_16x16x16_bf16 v[0:3], v[84:85], v[116:117], v[0:3]
    v_mfma_f32_16x16x16_bf16 v[4:7], v[84:85], v[118:119], v[4:7]
    v_mfma_f32_16x16x16_bf16 v[8:11], v[86:87], v[116:117], v[8:11]
    v_mfma_f32_16x16x16_bf16 v[12:15], v[86:87], v[118:119], v[12:15]
    v_mfma_f32_16x16x16_bf16 v[0:3], v[88:89], v[120:121], v[0:3]
    v_mfma_f32_16x16x16_bf16 v[4:7], v[88:89], v[122:123], v[4:7]
    v_mfma_f32_16x16x16_bf16 v[8:11], v[90:91], v[120:121], v[8:11]
    v_mfma_f32_16x16x16_bf16 v[12:15], v[90:91], v[122:123], v[12:15]
    v_mfma_f32_16x16x16_bf16 v[0:3], v[92:93], v[124:125], v[0:3]
    v_mfma_f32_16x16x16_bf16 v[4:7], v[92:93], v[126:127], v[4:7]
    v_mfma_f32_16x16x16_bf16 v[8:11], v[94:95], v[124:125], v[8:11]
    v_mfma_f32_16x16x16_bf16 v[12:15], v[94:95], v[126:127], v[12:15]
    s_waitcnt vmcnt(8) lgkmcnt(0)
    s_barrier
    ds_read_b64 v[64:65], v128 offset:16384
    ds_read_b64 v[66:67], v128 offset:20480
    ds_read_b128 v[96:99], v142 offset:32768
    ds_read_b64 v[68:69], v129 offset:16384
    ds_read_b64 v[70:71], v129 offset:20480
    ds_read_b128 v[100:103], v142 offset:36864
    ds_read_b64 v[72:73], v130 offset:16384
    ds_read_b64 v[74:75], v130 offset:20480
    ds_read_b128 v[104:107], v142 offset:40960
    ds_read_b64 v[76:77], v131 offset:16384
    ds_read_b64 v[78:79], v131 offset:20480
    ds_read_b128 v[108:111], v142 offset:45056
    ds_read_b64 v[80:81], v132 offset:16384
    ds_read_b64 v[82:83], v132 offset:20480
    ds_read_b128 v[112:115], v142 offset:49152
    ds_read_b64 v[84:85], v133 offset:16384
    ds_read_b64 v[86:87], v133 offset:20480
    ds_read_b128 v[116:119], v142 offset:53248
    ds_read_b64 v[88:89], v134 offset:16384
    ds_read_b64 v[90:91], v134 offset:20480
    ds_read_b128 v[120:123], v142 offset:57344
    ds_read_b64 v[92:93], v135 offset:16384
    ds_read_b64 v[94:95], v135 offset:20480
    ds_read_b128 v[124:127], v142 offset:61440
    v_perm_b32 v48, v20, v16, v139
    v_perm_b32 v49, v28, v24, v139
    v_perm_b32 v50, v20, v16, v140
    v_perm_b32 v51, v28, v24, v140
    v_perm_b32 v52, v21, v17, v139
    v_perm_b32 v53, v29, v25, v139
    v_perm_b32 v54, v21, v17, v140
    v_perm_b32 v55, v29, v25, v140
    v_perm_b32 v56, v22, v18, v139
    v_perm_b32 v57, v30, v26, v139
    v_perm_b32 v58, v22, v18, v140
    v_perm_b32 v59, v30, v26, v140
    v_perm_b32 v60, v23, v19, v139
    v_perm_b32 v61, v31, v27, v139
    v_perm_b32 v62, v23, v19, v140
    v_perm_b32 v63, v31, v27, v140
    ds_write_b128 v141, v[48:51] offset:0
    ds_write_b128 v141, v[52:55] offset:1024
    ds_write_b128 v141, v[56:59] offset:2048
    ds_write_b128 v141, v[60:63] offset:3072
    buffer_load_dwordx4 v[16:19], v136, s[8:11], 0 offen offset:0 nt
    buffer_load_dwordx4 v[20:23], v136, s[8:11], 0 offen offset:256 nt
    buffer_load_dwordx4 v[24:27], v136, s[8:11], 0 offen offset:512 nt
    buffer_load_dwordx4 v[28:31], v136, s[8:11], 0 offen offset:768 nt
    v_add_u32 v136, 0x8000, v136
    s_add_u32 m0, s28, 0
    s_nop 0
    buffer_load_dwordx4 v137, s[12:15], s18 offen lds
    s_add_u32 m0, s28, 1024
    s_nop 0
    buffer_load_dwordx4 v138, s[12:15], s18 offen lds
    s_add_u32 s18, s18, 0x100
    s_waitcnt lgkmcnt(4)
    v_mfma_f32_16x16x16_bf16 v[0:3], v[64:65], v[96:97], v[0:3]
    v_mfma_f32_16x16x16_bf16 v[4:7], v[64:65], v[98:99], v[4:7]
    v_mfma_f32_16x16x16_bf16 v[8:11], v[66:67], v[96:97], v[8:11]
    v_mfma_f32_16x16x16_bf16 v[12:15], v[66:67], v[98:99], v[12:15]
    v_mfma_f32_16x16x16_bf16 v[0:3], v[68:69], v[100:101], v[0:3]
    v_mfma_f32_16x16x16_bf16 v[4:7], v[68:69], v[102:103], v[4:7]
    v_mfma_f32_16x16x16_bf16 v[8:11], v[70:71], v[100:101], v[8:11]
    v_mfma_f32_16x16x16_bf16 v[12:15], v[70:71], v[102:103], v[12:15]
    v_mfma_f32_16x16x16_bf16 v[0:3], v[72:73], v[104:105], v[0:3]
    v_mfma_f32_16x16x16_bf16 v[4:7], v[72:73], v[106:107], v[4:7]
    v_mfma_f32_16x16x16_bf16 v[8:11], v[74:75], v[104:105], v[8:11]
    v_mfma_f32_16x16x16_bf16 v[12:15], v[74:75], v[106:107], v[12:15]
    v_mfma_f32_16x16x16_bf16 v[0:3], v[76:77], v[108:109], v[0:3]
    v_mfma_f32_16x16x16_bf16 v[4:7], v[76:77], v[110:111], v[4:7]
    v_mfma_f32_16x16x16_bf16 v[8:11], v[78:79], v[108:109], v[8:11]
    v_mfma_f32_16x16x16_bf16 v[12:15], v[78:79], v[110:111], v[12:15]
    v_mfma_f32_16x16x16_bf16 v[0:3], v[80:81], v[112:113], v[0:3]
    v_mfma_f32_16x16x16_bf16 v[4:7], v[80:81], v[114:115], v[4:7]
    v_mfma_f32_16x16x16_bf16 v[8:11], v[82:83], v[112:113], v[8:11]
    v_mfma_f32_16x16x16_bf16 v[12:15], v[82:83], v[114:115], v[12:15]
    v_mfma_f32_16x16x16_bf16 v[0:3], v[84:85], v[116:117], v[0:3]
    v_mfma_f32_16x16x16_bf16 v[4:7], v[84:85], v[118:119], v[4:7]
    v_mfma_f32_16x16x16_bf16 v[8:11], v[86:87], v[116:117], v[8:11]
    v_mfma_f32_16x16x16_bf16 v[12:15], v[86:87], v[118:119], v[12:15]
    v_mfma_f32_16x16x16_bf16 v[0:3], v[88:89], v[120:121], v[0:3]
    v_mfma_f32_16x16x16_bf16 v[4:7], v[88:89], v[122:123], v[4:7]
    v_mfma_f32_16x16x16_bf16 v[8:11], v[90:91], v[120:121], v[8:11]
    v_mfma_f32_16x16x16_bf16 v[12:15], v[90:91], v[122:123], v[12:15]
    v_mfma_f32_16x16x16_bf16 v[0:3], v[92:93], v[124:125], v[0:3]
    v_mfma_f32_16x16x16_bf16 v[4:7], v[92:93], v[126:127], v[4:7]
    v_mfma_f32_16x16x16_bf16 v[8:11], v[94:95], v[124:125], v[8:11]
    v_mfma_f32_16x16x16_bf16 v[12:15], v[94:95], v[126:127], v[12:15]
    s_waitcnt vmcnt(8) lgkmcnt(0)
    s_barrier
    ds_read_b64 v[64:65], v128 offset:32768
    ds_read_b64 v[66:67], v128 offset:36864
    ds_read_b128 v[96:99], v142 offset:0
    ds_read_b64 v[68:69], v129 offset:32768
    ds_read_b64 v[70:71], v129 offset:36864
    ds_read_b128 v[100:103], v142 offset:4096
    ds_read_b64 v[72:73], v130 offset:32768
    ds_read_b64 v[74:75], v130 offset:36864
    ds_read_b128 v[104:107], v142 offset:8192
    ds_read_b64 v[76:77], v131 offset:32768
    ds_read_b64 v[78:79], v131 offset:36864
    ds_read_b128 v[108:111], v142 offset:12288
    ds_read_b64 v[80:81], v132 offset:32768
    ds_read_b64 v[82:83], v132 offset:36864
    ds_read_b128 v[112:115], v142 offset:16384
    ds_read_b64 v[84:85], v133 offset:32768
    ds_read_b64 v[86:87], v133 offset:36864
    ds_read_b128 v[116:119], v142 offset:20480
    ds_read_b64 v[88:89], v134 offset:32768
    ds_read_b64 v[90:91], v134 offset:36864
    ds_read_b128 v[120:123], v142 offset:24576
    ds_read_b64 v[92:93], v135 offset:32768
    ds_read_b64 v[94:95], v135 offset:36864
    ds_read_b128 v[124:127], v142 offset:28672
    v_perm_b32 v48, v36, v32, v139
    v_perm_b32 v49, v44, v40, v139
    v_perm_b32 v50, v36, v32, v140
    v_perm_b32 v51, v44, v40, v140
    v_perm_b32 v52, v37, v33, v139
    v_perm_b32 v53, v45, v41, v139
    v_perm_b32 v54, v37, v33, v140
    v_perm_b32 v55, v45, v41, v140
    v_perm_b32 v56, v38, v34, v139
    v_perm_b32 v57, v46, v42, v139
    v_perm_b32 v58, v38, v34, v140
    v_perm_b32 v59, v46, v42, v140
    v_perm_b32 v60, v39, v35, v139
    v_perm_b32 v61, v47, v43, v139
    v_perm_b32 v62, v39, v35, v140
    v_perm_b32 v63, v47, v43, v140
    ds_write_b128 v141, v[48:51] offset:32768
    ds_write_b128 v141, v[52:55] offset:33792
    ds_write_b128 v141, v[56:59] offset:34816
    ds_write_b128 v141, v[60:63] offset:35840
    buffer_load_dwordx4 v[32:35], v136, s[8:11], 0 offen offset:0 nt
    buffer_load_dwordx4 v[36:39], v136, s[8:11], 0 offen offset:256 nt
    buffer_load_dwordx4 v[40:43], v136, s[8:11], 0 offen offset:512 nt
    buffer_load_dwordx4 v[44:47], v136, s[8:11], 0 offen offset:768 nt
    v_add_u32 v136, 0x8000, v136
    s_add_u32 m0, s28, 16384
    s_nop 0
    buffer_load_dwordx4 v137, s[12:15], s18 offen lds
    s_add_u32 m0, s28, 17408
    s_nop 0
    buffer_load_dwordx4 v138, s[12:15], s18 offen lds
    s_add_u32 s18, s18, 0x100
    s_waitcnt lgkmcnt(4)
    v_mfma_f32_16x16x16_bf16 v[0:3], v[64:65], v[96:97], v[0:3]
    v_mfma_f32_16x16x16_bf16 v[4:7], v[64:65], v[98:99], v[4:7]
    v_mfma_f32_16x16x16_bf16 v[8:11], v[66:67], v[96:97], v[8:11]
    v_mfma_f32_16x16x16_bf16 v[12:15], v[66:67], v[98:99], v[12:15]
    v_mfma_f32_16x16x16_bf16 v[0:3], v[68:69], v[100:101], v[0:3]
    v_mfma_f32_16x16x16_bf16 v[4:7], v[68:69], v[102:103], v[4:7]
    v_mfma_f32_16x16x16_bf16 v[8:11], v[70:71], v[100:101], v[8:11]
    v_mfma_f32_16x16x16_bf16 v[12:15], v[70:71], v[102:103], v[12:15]
    v_mfma_f32_16x16x16_bf16 v[0:3], v[72:73], v[104:105], v[0:3]
    v_mfma_f32_16x16x16_bf16 v[4:7], v[72:73], v[106:107], v[4:7]
    v_mfma_f32_16x16x16_bf16 v[8:11], v[74:75], v[104:105], v[8:11]
    v_mfma_f32_16x16x16_bf16 v[12:15], v[74:75], v[106:107], v[12:15]
    v_mfma_f32_16x16x16_bf16 v[0:3], v[76:77], v[108:109], v[0:3]
    v_mfma_f32_16x16x16_bf16 v[4:7], v[76:77], v[110:111], v[4:7]
    v_mfma_f32_16x16x16_bf16 v[8:11], v[78:79], v[108:109], v[8:11]
    v_mfma_f32_16x16x16_bf16 v[12:15], v[78:79], v[110:111], v[12:15]
    v_mfma_f32_16x16x16_bf16 v[0:3], v[80:81], v[112:113], v[0:3]
    v_mfma_f32_16x16x16_bf16 v[4:7], v[80:81], v[114:115], v[4:7]
    v_mfma_f32_16x16x16_bf16 v[8:11], v[82:83], v[112:113], v[8:11]
    v_mfma_f32_16x16x16_bf16 v[12:15], v[82:83], v[114:115], v[12:15]
    v_mfma_f32_16x16x16_bf16 v[0:3], v[84:85], v[116:117], v[0:3]
    v_mfma_f32_16x16x16_bf16 v[4:7], v[84:85], v[118:119], v[4:7]
    v_mfma_f32_16x16x16_bf16 v[8:11], v[86:87], v[116:117], v[8:11]
    v_mfma_f32_16x16x16_bf16 v[12:15], v[86:87], v[118:119], v[12:15]
    v_mfma_f32_16x16x16_bf16 v[0:3], v[88:89], v[120:121], v[0:3]
    v_mfma_f32_16x16x16_bf16 v[4:7], v[88:89], v[122:123], v[4:7]
    v_mfma_f32_16x16x16_bf16 v[8:11], v[90:91], v[120:121], v[8:11]
    v_mfma_f32_16x16x16_bf16 v[12:15], v[90:91], v[122:123], v[12:15]
    v_mfma_f32_16x16x16_bf16 v[0:3], v[92:93], v[124:125], v[0:3]
    v_mfma_f32_16x16x16_bf16 v[4:7], v[92:93], v[126:127], v[4:7]
    v_mfma_f32_16x16x16_bf16 v[8:11], v[94:95], v[124:125], v[8:11]
    v_mfma_f32_16x16x16_bf16 v[12:15], v[94:95], v[126:127], v[12:15]
    s_sub_u32 s19, s19, 1
    s_cmp_lg_u32 s19, 0
    s_cbranch_scc1 L_loop
    s_waitcnt vmcnt(8) lgkmcnt(0)
    s_barrier
    ds_read_b64 v[64:65], v128 offset:49152
    ds_read_b64 v[66:67], v128 offset:53248
    ds_read_b128 v[96:99], v142 offset:32768
    ds_read_b64 v[68:69], v129 offset:49152
    ds_read_b64 v[70:71], v129 offset:53248
    ds_read_b128 v[100:103], v142 offset:36864
    ds_read_b64 v[72:73], v130 offset:49152
    ds_read_b64 v[74:75], v130 offset:53248
    ds_read_b128 v[104:107], v142 offset:40960
    ds_read_b64 v[76:77], v131 offset:49152
    ds_read_b64 v[78:79], v131 offset:53248
    ds_read_b128 v[108:111], v142 offset:45056
    ds_read_b64 v[80:81], v132 offset:49152
    ds_read_b64 v[82:83], v132 offset:53248
    ds_read_b128 v[112:115], v142 offset:49152
    ds_read_b64 v[84:85], v133 offset:49152
    ds_read_b64 v[86:87], v133 offset:53248
    ds_read_b128 v[116:119], v142 offset:53248
    ds_read_b64 v[88:89], v134 offset:49152
    ds_read_b64 v[90:91], v134 offset:53248
    ds_read_b128 v[120:123], v142 offset:57344
    ds_read_b64 v[92:93], v135 offset:49152
    ds_read_b64 v[94:95], v135 offset:53248
    ds_read_b128 v[124:127], v142 offset:61440
    v_perm_b32 v48, v20, v16, v139
    v_perm_b32 v49, v28, v24, v139
    v_perm_b32 v50, v20, v16, v140
    v_perm_b32 v51, v28, v24, v140
    v_perm_b32 v52, v21, v17, v139
    v_perm_b32 v53, v29, v25, v139
    v_perm_b32 v54, v21, v17, v140
    v_perm_b32 v55, v29, v25, v140
    v_perm_b32 v56, v22, v18, v139
    v_perm_b32 v57, v30, v26, v139
    v_perm_b32 v58, v22, v18, v140
    v_perm_b32 v59, v30, v26, v140
    v_perm_b32 v60, v23, v19, v139
    v_perm_b32 v61, v31, v27, v139
    v_perm_b32 v62, v23, v19, v140
    v_perm_b32 v63, v31, v27, v140
    ds_write_b128 v141, v[48:51] offset:0
    ds_write_b128 v141, v[52:55] offset:1024
    ds_write_b128 v141, v[56:59] offset:2048
    ds_write_b128 v141, v[60:63] offset:3072
    buffer_load_dwordx4 v[16:19], v136, s[8:11], 0 offen offset:0 nt
    buffer_load_dwordx4 v[20:23], v136, s[8:11], 0 offen offset:256 nt
    buffer_load_dwordx4 v[24:27], v136, s[8:11], 0 offen offset:512 nt
    buffer_load_dwordx4 v[28:31], v136, s[8:11], 0 offen offset:768 nt
    v_add_u32 v136, 0x8000, v136
    s_add_u32 m0, s28, 32768
    s_nop 0
    buffer_load_dwordx4 v137, s[12:15], s18 offen lds
    s_add_u32 m0, s28, 33792
    s_nop 0
    buffer_load_dwordx4 v138, s[12:15], s18 offen lds
    s_add_u32 s18, s18, 0x100
    s_waitcnt lgkmcnt(4)
    v_mfma_f32_16x16x16_bf16 v[0:3], v[64:65], v[96:97], v[0:3]
    v_mfma_f32_16x16x16_bf16 v[4:7], v[64:65], v[98:99], v[4:7]
    v_mfma_f32_16x16x16_bf16 v[8:11], v[66:67], v[96:97], v[8:11]
    v_mfma_f32_16x16x16_bf16 v[12:15], v[66:67], v[98:99], v[12:15]
    v_mfma_f32_16x16x16_bf16 v[0:3], v[68:69], v[100:101], v[0:3]
    v_mfma_f32_16x16x16_bf16 v[4:7], v[68:69], v[102:103], v[4:7]
    v_mfma_f32_16x16x16_bf16 v[8:11], v[70:71], v[100:101], v[8:11]
    v_mfma_f32_16x16x16_bf16 v[12:15], v[70:71], v[102:103], v[12:15]
    v_mfma_f32_16x16x16_bf16 v[0:3], v[72:73], v[104:105], v[0:3]
    v_mfma_f32_16x16x16_bf16 v[4:7], v[72:73], v[106:107], v[4:7]
    v_mfma_f32_16x16x16_bf16 v[8:11], v[74:75], v[104:105], v[8:11]
    v_mfma_f32_16x16x16_bf16 v[12:15], v[74:75], v[106:107], v[12:15]
    v_mfma_f32_16x16x16_bf16 v[0:3], v[76:77], v[108:109], v[0:3]
    v_mfma_f32_16x16x16_bf16 v[4:7], v[76:77], v[110:111], v[4:7]
    v_mfma_f32_16x16x16_bf16 v[8:11], v[78:79], v[108:109], v[8:11]
    v_mfma_f32_16x16x16_bf16 v[12:15], v[78:79], v[110:111], v[12:15]
    v_mfma_f32_16x16x16_bf16 v[0:3], v[80:81], v[112:113], v[0:3]
    v_mfma_f32_16x16x16_bf16 v[4:7], v[80:81], v[114:115], v[4:7]
    v_mfma_f32_16x16x16_bf16 v[8:11], v[82:83], v[112:113], v[8:11]
    v_mfma_f32_16x16x16_bf16 v[12:15], v[82:83], v[114:115], v[12:15]
    v_mfma_f32_16x16x16_bf16 v[0:3], v[84:85], v[116:117], v[0:3]
    v_mfma_f32_16x16x16_bf16 v[4:7], v[84:85], v[118:119], v[4:7]
    v_mfma_f32_16x16x16_bf16 v[8:11], v[86:87], v[116:117], v[8:11]
    v_mfma_f32_16x16x16_bf16 v[12:15], v[86:87], v[118:119], v[12:15]
    v_mfma_f32_16x16x16_bf16 v[0:3], v[88:89], v[120:121], v[0:3]
    v_mfma_f32_16x16x16_bf16 v[4:7], v[88:89], v[122:123], v[4:7]
    v_mfma_f32_16x16x16_bf16 v[8:11], v[90:91], v[120:121], v[8:11]
    v_mfma_f32_16x16x16_bf16 v[12:15], v[90:91], v[122:123], v[12:15]
    v_mfma_f32_16x16x16_bf16 v[0:3], v[92:93], v[124:125], v[0:3]
    v_mfma_f32_16x16x16_bf16 v[4:7], v[92:93], v[126:127], v[4:7]
    v_mfma_f32_16x16x16_bf16 v[8:11], v[94:95], v[124:125], v[8:11]
    v_mfma_f32_16x16x16_bf16 v[12:15], v[94:95], v[126:127], v[12:15]
    s_waitcnt vmcnt(8) lgkmcnt(0)
    s_barrier
    ds_read_b64 v[64:65], v128 offset:0
    ds_read_b64 v[66:67], v128 offset:4096
    ds_read_b128 v[96:99], v142 offset:0
    ds_read_b64 v[68:69], v129 offset:0
    ds_read_b64 v[70:71], v129 offset:4096
    ds_read_b128 v[100:103], v142 offset:4096
    ds_read_b64 v[72:73], v130 offset:0
    ds_read_b64 v[74:75], v130 offset:4096
    ds_read_b128 v[104:107], v142 offset:8192
    ds_read_b64 v[76:77], v131 offset:0
    ds_read_b64 v[78:79], v131 offset:4096
    ds_read_b128 v[108:111], v142 offset:12288
    ds_read_b64 v[80:81], v132 offset:0
    ds_read_b64 v[82:83], v132 offset:4096
    ds_read_b128 v[112:115], v142 offset:16384
    ds_read_b64 v[84:85], v133 offset:0
    ds_read_b64 v[86:87], v133 offset:4096
    ds_read_b128 v[116:119], v142 offset:20480
    ds_read_b64 v[88:89], v134 offset:0
    ds_read_b64 v[90:91], v134 offset:4096
    ds_read_b128 v[120:123], v142 offset:24576
    ds_read_b64 v[92:93], v135 offset:0
    ds_read_b64 v[94:95], v135 offset:4096
    ds_read_b128 v[124:127], v142 offset:28672
    v_perm_b32 v48, v36, v32, v139
    v_perm_b32 v49, v44, v40, v139
    v_perm_b32 v50, v36, v32, v140
    v_perm_b32 v51, v44, v40, v140
    v_perm_b32 v52, v37, v33, v139
    v_perm_b32 v53, v45, v41, v139
    v_perm_b32 v54, v37, v33, v140
    v_perm_b32 v55, v45, v41, v140
    v_perm_b32 v56, v38, v34, v139
    v_perm_b32 v57, v46, v42, v139
    v_perm_b32 v58, v38, v34, v140
    v_perm_b32 v59, v46, v42, v140
    v_perm_b32 v60, v39, v35, v139
    v_perm_b32 v61, v47, v43, v139
    v_perm_b32 v62, v39, v35, v140
    v_perm_b32 v63, v47, v43, v140
    ds_write_b128 v141, v[48:51] offset:32768
    ds_write_b128 v141, v[52:55] offset:33792
    ds_write_b128 v141, v[56:59] offset:34816
    ds_write_b128 v141, v[60:63] offset:35840
    buffer_load_dwordx4 v[32:35], v136, s[8:11], 0 offen offset:0 nt
    buffer_load_dwordx4 v[36:39], v136, s[8:11], 0 offen offset:256 nt
    buffer_load_dwordx4 v[40:43], v136, s[8:11], 0 offen offset:512 nt
    buffer_load_dwordx4 v[44:47], v136, s[8:11], 0 offen offset:768 nt
    v_add_u32 v136, 0x8000, v136
    s_add_u32 m0, s28, 49152
    s_nop 0
    buffer_load_dwordx4 v137, s[12:15], s18 offen lds
    s_add_u32 m0, s28, 50176
    s_nop 0
    buffer_load_dwordx4 v138, s[12:15], s18 offen lds
    s_add_u32 s18, s18, 0x100
    s_waitcnt lgkmcnt(4)
    v_mfma_f32_16x16x16_bf16 v[0:3], v[64:65], v[96:97], v[0:3]
    v_mfma_f32_16x16x16_bf16 v[4:7], v[64:65], v[98:99], v[4:7]
    v_mfma_f32_16x16x16_bf16 v[8:11], v[66:67], v[96:97], v[8:11]
    v_mfma_f32_16x16x16_bf16 v[12:15], v[66:67], v[98:99], v[12:15]
    v_mfma_f32_16x16x16_bf16 v[0:3], v[68:69], v[100:101], v[0:3]
    v_mfma_f32_16x16x16_bf16 v[4:7], v[68:69], v[102:103], v[4:7]
    v_mfma_f32_16x16x16_bf16 v[8:11], v[70:71], v[100:101], v[8:11]
    v_mfma_f32_16x16x16_bf16 v[12:15], v[70:71], v[102:103], v[12:15]
    v_mfma_f32_16x16x16_bf16 v[0:3], v[72:73], v[104:105], v[0:3]
    v_mfma_f32_16x16x16_bf16 v[4:7], v[72:73], v[106:107], v[4:7]
    v_mfma_f32_16x16x16_bf16 v[8:11], v[74:75], v[104:105], v[8:11]
    v_mfma_f32_16x16x16_bf16 v[12:15], v[74:75], v[106:107], v[12:15]
    v_mfma_f32_16x16x16_bf16 v[0:3], v[76:77], v[108:109], v[0:3]
    v_mfma_f32_16x16x16_bf16 v[4:7], v[76:77], v[110:111], v[4:7]
    v_mfma_f32_16x16x16_bf16 v[8:11], v[78:79], v[108:109], v[8:11]
    v_mfma_f32_16x16x16_bf16 v[12:15], v[78:79], v[110:111], v[12:15]
    v_mfma_f32_16x16x16_bf16 v[0:3], v[80:81], v[112:113], v[0:3]
    v_mfma_f32_16x16x16_bf16 v[4:7], v[80:81], v[114:115], v[4:7]
    v_mfma_f32_16x16x16_bf16 v[8:11], v[82:83], v[112:113], v[8:11]
    v_mfma_f32_16x16x16_bf16 v[12:15], v[82:83], v[114:115], v[12:15]
    v_mfma_f32_16x16x16_bf16 v[0:3], v[84:85], v[116:117], v[0:3]
    v_mfma_f32_16x16x16_bf16 v[4:7], v[84:85], v[118:119], v[4:7]
    v_mfma_f32_16x16x16_bf16 v[8:11], v[86:87], v[116:117], v[8:11]
    v_mfma_f32_16x16x16_bf16 v[12:15], v[86:87], v[118:119], v[12:15]
    v_mfma_f32_16x16x16_bf16 v[0:3], v[88:89], v[120:121], v[0:3]
    v_mfma_f32_16x16x16_bf16 v[4:7], v[88:89], v[122:123], v[4:7]
    v_mfma_f32_16x16x16_bf16 v[8:11], v[90:91], v[120:121], v[8:11]
    v_mfma_f32_16x16x16_bf16 v[12:15], v[90:91], v[122:123], v[12:15]
    v_mfma_f32_16x16x16_bf16 v[0:3], v[92:93], v[124:125], v[0:3]
    v_mfma_f32_16x16x16_bf16 v[4:7], v[92:93], v[126:127], v[4:7]
    v_mfma_f32_16x16x16_bf16 v[8:11], v[94:95], v[124:125], v[8:11]
    v_mfma_f32_16x16x16_bf16 v[12:15], v[94:95], v[126:127], v[12:15]
    s_waitcnt vmcnt(8) lgkmcnt(0)
    s_barrier
    ds_read_b64 v[64:65], v128 offset:16384
    ds_read_b64 v[66:67], v128 offset:20480
    ds_read_b128 v[96:99], v142 offset:32768
    ds_read_b64 v[68:69], v129 offset:16384
    ds_read_b64 v[70:71], v129 offset:20480
    ds_read_b128 v[100:103], v142 offset:36864
    ds_read_b64 v[72:73], v130 offset:16384
    ds_read_b64 v[74:75], v130 offset:20480
    ds_read_b128 v[104:107], v142 offset:40960
    ds_read_b64 v[76:77], v131 offset:16384
    ds_read_b64 v[78:79], v131 offset:20480
    ds_read_b128 v[108:111], v142 offset:45056
    ds_read_b64 v[80:81], v132 offset:16384
    ds_read_b64 v[82:83], v132 offset:20480
    ds_read_b128 v[112:115], v142 offset:49152
    ds_read_b64 v[84:85], v133 offset:16384
    ds_read_b64 v[86:87], v133 offset:20480
    ds_read_b128 v[116:119], v142 offset:53248
    ds_read_b64 v[88:89], v134 offset:16384
    ds_read_b64 v[90:91], v134 offset:20480
    ds_read_b128 v[120:123], v142 offset:57344
    ds_read_b64 v[92:93], v135 offset:16384
    ds_read_b64 v[94:95], v135 offset:20480
    ds_read_b128 v[124:127], v142 offset:61440
    v_perm_b32 v48, v20, v16, v139
    v_perm_b32 v49, v28, v24, v139
    v_perm_b32 v50, v20, v16, v140
    v_perm_b32 v51, v28, v24, v140
    v_perm_b32 v52, v21, v17, v139
    v_perm_b32 v53, v29, v25, v139
    v_perm_b32 v54, v21, v17, v140
    v_perm_b32 v55, v29, v25, v140
    v_perm_b32 v56, v22, v18, v139
    v_perm_b32 v57, v30, v26, v139
    v_perm_b32 v58, v22, v18, v140
    v_perm_b32 v59, v30, v26, v140
    v_perm_b32 v60, v23, v19, v139
    v_perm_b32 v61, v31, v27, v139
    v_perm_b32 v62, v23, v19, v140
    v_perm_b32 v63, v31, v27, v140
    ds_write_b128 v141, v[48:51] offset:0
    ds_write_b128 v141, v[52:55] offset:1024
    ds_write_b128 v141, v[56:59] offset:2048
    ds_write_b128 v141, v[60:63] offset:3072
    s_waitcnt lgkmcnt(4)
    v_mfma_f32_16x16x16_bf16 v[0:3], v[64:65], v[96:97], v[0:3]
    v_mfma_f32_16x16x16_bf16 v[4:7], v[64:65], v[98:99], v[4:7]
    v_mfma_f32_16x16x16_bf16 v[8:11], v[66:67], v[96:97], v[8:11]
    v_mfma_f32_16x16x16_bf16 v[12:15], v[66:67], v[98:99], v[12:15]
    v_mfma_f32_16x16x16_bf16 v[0:3], v[68:69], v[100:101], v[0:3]
    v_mfma_f32_16x16x16_bf16 v[4:7], v[68:69], v[102:103], v[4:7]
    v_mfma_f32_16x16x16_bf16 v[8:11], v[70:71], v[100:101], v[8:11]
    v_mfma_f32_16x16x16_bf16 v[12:15], v[70:71], v[102:103], v[12:15]
    v_mfma_f32_16x16x16_bf16 v[0:3], v[72:73], v[104:105], v[0:3]
    v_mfma_f32_16x16x16_bf16 v[4:7], v[72:73], v[106:107], v[4:7]
    v_mfma_f32_16x16x16_bf16 v[8:11], v[74:75], v[104:105], v[8:11]
    v_mfma_f32_16x16x16_bf16 v[12:15], v[74:75], v[106:107], v[12:15]
    v_mfma_f32_16x16x16_bf16 v[0:3], v[76:77], v[108:109], v[0:3]
    v_mfma_f32_16x16x16_bf16 v[4:7], v[76:77], v[110:111], v[4:7]
    v_mfma_f32_16x16x16_bf16 v[8:11], v[78:79], v[108:109], v[8:11]
    v_mfma_f32_16x16x16_bf16 v[12:15], v[78:79], v[110:111], v[12:15]
    v_mfma_f32_16x16x16_bf16 v[0:3], v[80:81], v[112:113], v[0:3]
    v_mfma_f32_16x16x16_bf16 v[4:7], v[80:81], v[114:115], v[4:7]
    v_mfma_f32_16x16x16_bf16 v[8:11], v[82:83], v[112:113], v[8:11]
    v_mfma_f32_16x16x16_bf16 v[12:15], v[82:83], v[114:115], v[12:15]
    v_mfma_f32_16x16x16_bf16 v[0:3], v[84:85], v[116:117], v[0:3]
    v_mfma_f32_16x16x16_bf16 v[4:7], v[84:85], v[118:119], v[4:7]
    v_mfma_f32_16x16x16_bf16 v[8:11], v[86:87], v[116:117], v[8:11]
    v_mfma_f32_16x16x16_bf16 v[12:15], v[86:87], v[118:119], v[12:15]
    v_mfma_f32_16x16x16_bf16 v[0:3], v[88:89], v[120:121], v[0:3]
    v_mfma_f32_16x16x16_bf16 v[4:7], v[88:89], v[122:123], v[4:7]
    v_mfma_f32_16x16x16_bf16 v[8:11], v[90:91], v[120:121], v[8:11]
    v_mfma_f32_16x16x16_bf16 v[12:15], v[90:91], v[122:123], v[12:15]
    v_mfma_f32_16x16x16_bf16 v[0:3], v[92:93], v[124:125], v[0:3]
    v_mfma_f32_16x16x16_bf16 v[4:7], v[92:93], v[126:127], v[4:7]
    v_mfma_f32_16x16x16_bf16 v[8:11], v[94:95], v[124:125], v[8:11]
    v_mfma_f32_16x16x16_bf16 v[12:15], v[94:95], v[126:127], v[12:15]
    s_waitcnt vmcnt(2) lgkmcnt(0)
    s_barrier
    ds_read_b64 v[64:65], v128 offset:32768
    ds_read_b64 v[66:67], v128 offset:36864
    ds_read_b128 v[96:99], v142 offset:0
    ds_read_b64 v[68:69], v129 offset:32768
    ds_read_b64 v[70:71], v129 offset:36864
    ds_read_b128 v[100:103], v142 offset:4096
    ds_read_b64 v[72:73], v130 offset:32768
    ds_read_b64 v[74:75], v130 offset:36864
    ds_read_b128 v[104:107], v142 offset:8192
    ds_read_b64 v[76:77], v131 offset:32768
    ds_read_b64 v[78:79], v131 offset:36864
    ds_read_b128 v[108:111], v142 offset:12288
    ds_read_b64 v[80:81], v132 offset:32768
    ds_read_b64 v[82:83], v132 offset:36864
    ds_read_b128 v[112:115], v142 offset:16384
    ds_read_b64 v[84:85], v133 offset:32768
    ds_read_b64 v[86:87], v133 offset:36864
    ds_read_b128 v[116:119], v142 offset:20480
    ds_read_b64 v[88:89], v134 offset:32768
    ds_read_b64 v[90:91], v134 offset:36864
    ds_read_b128 v[120:123], v142 offset:24576
    ds_read_b64 v[92:93], v135 offset:32768
    ds_read_b64 v[94:95], v135 offset:36864
    ds_read_b128 v[124:127], v142 offset:28672
    v_perm_b32 v48, v36, v32, v139
    v_perm_b32 v49, v44, v40, v139
    v_perm_b32 v50, v36, v32, v140
    v_perm_b32 v51, v44, v40, v140
    v_perm_b32 v52, v37, v33, v139
    v_perm_b32 v53, v45, v41, v139
    v_perm_b32 v54, v37, v33, v140
    v_perm_b32 v55, v45, v41, v140
    v_perm_b32 v56, v38, v34, v139
    v_perm_b32 v57, v46, v42, v139
    v_perm_b32 v58, v38, v34, v140
    v_perm_b32 v59, v46, v42, v140
    v_perm_b32 v60, v39, v35, v139
    v_perm_b32 v61, v47, v43, v139
    v_perm_b32 v62, v39, v35, v140
    v_perm_b32 v63, v47, v43, v140
    ds_write_b128 v141, v[48:51] offset:32768
    ds_write_b128 v141, v[52:55] offset:33792
    ds_write_b128 v141, v[56:59] offset:34816
    ds_write_b128 v141, v[60:63] offset:35840
    s_waitcnt lgkmcnt(4)
    v_mfma_f32_16x16x16_bf16 v[0:3], v[64:65], v[96:97], v[0:3]
    v_mfma_f32_16x16x16_bf16 v[4:7], v[64:65], v[98:99], v[4:7]
    v_mfma_f32_16x16x16_bf16 v[8:11], v[66:67], v[96:97], v[8:11]
    v_mfma_f32_16x16x16_bf16 v[12:15], v[66:67], v[98:99], v[12:15]
    v_mfma_f32_16x16x16_bf16 v[0:3], v[68:69], v[100:101], v[0:3]
    v_mfma_f32_16x16x16_bf16 v[4:7], v[68:69], v[102:103], v[4:7]
    v_mfma_f32_16x16x16_bf16 v[8:11], v[70:71], v[100:101], v[8:11]
    v_mfma_f32_16x16x16_bf16 v[12:15], v[70:71], v[102:103], v[12:15]
    v_mfma_f32_16x16x16_bf16 v[0:3], v[72:73], v[104:105], v[0:3]
    v_mfma_f32_16x16x16_bf16 v[4:7], v[72:73], v[106:107], v[4:7]
    v_mfma_f32_16x16x16_bf16 v[8:11], v[74:75], v[104:105], v[8:11]
    v_mfma_f32_16x16x16_bf16 v[12:15], v[74:75], v[106:107], v[12:15]
    v_mfma_f32_16x16x16_bf16 v[0:3], v[76:77], v[108:109], v[0:3]
    v_mfma_f32_16x16x16_bf16 v[4:7], v[76:77], v[110:111], v[4:7]
    v_mfma_f32_16x16x16_bf16 v[8:11], v[78:79], v[108:109], v[8:11]
    v_mfma_f32_16x16x16_bf16 v[12:15], v[78:79], v[110:111], v[12:15]
    v_mfma_f32_16x16x16_bf16 v[0:3], v[80:81], v[112:113], v[0:3]
    v_mfma_f32_16x16x16_bf16 v[4:7], v[80:81], v[114:115], v[4:7]
    v_mfma_f32_16x16x16_bf16 v[8:11], v[82:83], v[112:113], v[8:11]
    v_mfma_f32_16x16x16_bf16 v[12:15], v[82:83], v[114:115], v[12:15]
    v_mfma_f32_16x16x16_bf16 v[0:3], v[84:85], v[116:117], v[0:3]
    v_mfma_f32_16x16x16_bf16 v[4:7], v[84:85], v[118:119], v[4:7]
    v_mfma_f32_16x16x16_bf16 v[8:11], v[86:87], v[116:117], v[8:11]
    v_mfma_f32_16x16x16_bf16 v[12:15], v[86:87], v[118:119], v[12:15]
    v_mfma_f32_16x16x16_bf16 v[0:3], v[88:89], v[120:121], v[0:3]
    v_mfma_f32_16x16x16_bf16 v[4:7], v[88:89], v[122:123], v[4:7]
    v_mfma_f32_16x16x16_bf16 v[8:11], v[90:91], v[120:121], v[8:11]
    v_mfma_f32_16x16x16_bf16 v[12:15], v[90:91], v[122:123], v[12:15]
    v_mfma_f32_16x16x16_bf16 v[0:3], v[92:93], v[124:125], v[0:3]
    v_mfma_f32_16x16x16_bf16 v[4:7], v[92:93], v[126:127], v[4:7]
    v_mfma_f32_16x16x16_bf16 v[8:11], v[94:95], v[124:125], v[8:11]
    v_mfma_f32_16x16x16_bf16 v[12:15], v[94:95], v[126:127], v[12:15]
    s_waitcnt vmcnt(0) lgkmcnt(0)
    s_barrier
    ds_read_b64 v[64:65], v128 offset:49152
    ds_read_b64 v[66:67], v128 offset:53248
    ds_read_b128 v[96:99], v142 offset:32768
    ds_read_b64 v[68:69], v129 offset:49152
    ds_read_b64 v[70:71], v129 offset:53248
    ds_read_b128 v[100:103], v142 offset:36864
    ds_read_b64 v[72:73], v130 offset:49152
    ds_read_b64 v[74:75], v130 offset:53248
    ds_read_b128 v[104:107], v142 offset:40960
    ds_read_b64 v[76:77], v131 offset:49152
    ds_read_b64 v[78:79], v131 offset:53248
    ds_read_b128 v[108:111], v142 offset:45056
    ds_read_b64 v[80:81], v132 offset:49152
    ds_read_b64 v[82:83], v132 offset:53248
    ds_read_b128 v[112:115], v142 offset:49152
    ds_read_b64 v[84:85], v133 offset:49152
    ds_read_b64 v[86:87], v133 offset:53248
    ds_read_b128 v[116:119], v142 offset:53248
    ds_read_b64 v[88:89], v134 offset:49152
    ds_read_b64 v[90:91], v134 offset:53248
    ds_read_b128 v[120:123], v142 offset:57344
    ds_read_b64 v[92:93], v135 offset:49152
    ds_read_b64 v[94:95], v135 offset:53248
    ds_read_b128 v[124:127], v142 offset:61440
    s_waitcnt lgkmcnt(0)
    v_mfma_f32_16x16x16_bf16 v[0:3], v[64:65], v[96:97], v[0:3]
    v_mfma_f32_16x16x16_bf16 v[4:7], v[64:65], v[98:99], v[4:7]
    v_mfma_f32_16x16x16_bf16 v[8:11], v[66:67], v[96:97], v[8:11]
    v_mfma_f32_16x16x16_bf16 v[12:15], v[66:67], v[98:99], v[12:15]
    v_mfma_f32_16x16x16_bf16 v[0:3], v[68:69], v[100:101], v[0:3]
    v_mfma_f32_16x16x16_bf16 v[4:7], v[68:69], v[102:103], v[4:7]
    v_mfma_f32_16x16x16_bf16 v[8:11], v[70:71], v[100:101], v[8:11]
    v_mfma_f32_16x16x16_bf16 v[12:15], v[70:71], v[102:103], v[12:15]
    v_mfma_f32_16x16x16_bf16 v[0:3], v[72:73], v[104:105], v[0:3]
    v_mfma_f32_16x16x16_bf16 v[4:7], v[72:73], v[106:107], v[4:7]
    v_mfma_f32_16x16x16_bf16 v[8:11], v[74:75], v[104:105], v[8:11]
    v_mfma_f32_16x16x16_bf16 v[12:15], v[74:75], v[106:107], v[12:15]
    v_mfma_f32_16x16x16_bf16 v[0:3], v[76:77], v[108:109], v[0:3]
    v_mfma_f32_16x16x16_bf16 v[4:7], v[76:77], v[110:111], v[4:7]
    v_mfma_f32_16x16x16_bf16 v[8:11], v[78:79], v[108:109], v[8:11]
    v_mfma_f32_16x16x16_bf16 v[12:15], v[78:79], v[110:111], v[12:15]
    v_mfma_f32_16x16x16_bf16 v[0:3], v[80:81], v[112:113], v[0:3]
    v_mfma_f32_16x16x16_bf16 v[4:7], v[80:81], v[114:115], v[4:7]
    v_mfma_f32_16x16x16_bf16 v[8:11], v[82:83], v[112:113], v[8:11]
    v_mfma_f32_16x16x16_bf16 v[12:15], v[82:83], v[114:115], v[12:15]
    v_mfma_f32_16x16x16_bf16 v[0:3], v[84:85], v[116:117], v[0:3]
    v_mfma_f32_16x16x16_bf16 v[4:7], v[84:85], v[118:119], v[4:7]
    v_mfma_f32_16x16x16_bf16 v[8:11], v[86:87], v[116:117], v[8:11]
    v_mfma_f32_16x16x16_bf16 v[12:15], v[86:87], v[118:119], v[12:15]
    v_mfma_f32_16x16x16_bf16 v[0:3], v[88:89], v[120:121], v[0:3]
    v_mfma_f32_16x16x16_bf16 v[4:7], v[88:89], v[122:123], v[4:7]
    v_mfma_f32_16x16x16_bf16 v[8:11], v[90:91], v[120:121], v[8:11]
    v_mfma_f32_16x16x16_bf16 v[12:15], v[90:91], v[122:123], v[12:15]
    v_mfma_f32_16x16x16_bf16 v[0:3], v[92:93], v[124:125], v[0:3]
    v_mfma_f32_16x16x16_bf16 v[4:7], v[92:93], v[126:127], v[4:7]
    v_mfma_f32_16x16x16_bf16 v[8:11], v[94:95], v[124:125], v[8:11]
    v_mfma_f32_16x16x16_bf16 v[12:15], v[94:95], v[126:127], v[12:15]
    s_mov_b32 s44, s24
    s_and_b32 s45, s25, 0xffff
    s_mov_b32 s46, 8388608
    s_mov_b32 s47, 0x00020000
    s_mov_b32 s52, s22
    s_and_b32 s53, s23, 0xffff
    s_mov_b32 s54, 256
    s_mov_b32 s55, 0x00020000
    s_lshr_b32 s26, s6, 2
    s_lshl_b32 s26, s26, 14
    s_and_b32 s27, s6, 3
    s_lshl_b32 s27, s27, 11
    s_add_u32 s26, s26, s27
    s_lshl_b32 s27, s2, 15
    s_add_u32 s26, s26, s27
    v_add_u32 v148, s26, v146
    s_mov_b32 s27, 0x2000
    s_nop 7
    buffer_store_dwordx4 v[0:3], v148, s[44:47], 0 offen offset:0 sc1
    buffer_store_dwordx4 v[4:7], v148, s[44:47], 0 offen offset:1024 sc1
    buffer_store_dwordx4 v[8:11], v148, s[44:47], s27 offen offset:0 sc1
    buffer_store_dwordx4 v[12:15], v148, s[44:47], s27 offen offset:1024 sc1
    s_waitcnt vmcnt(0)
    s_barrier
    s_cmp_lg_u32 s6, 0
    s_cbranch_scc1 L_noatom
    s_lshl_b32 s26, s3, 2
    v_mov_b32 v148, 1
    v_mov_b32 v149, s26
    v_mov_b32 v150, 69632
    s_mov_b64 s[40:41], exec
    s_mov_b64 exec, 1
    buffer_atomic_add v148, v149, s[52:55], 0 offen sc0 sc1
    s_waitcnt vmcnt(0)
    ds_write_b32 v150, v148
    s_mov_b64 exec, s[40:41]
    s_waitcnt lgkmcnt(0)
L_noatom:
    s_barrier
    v_mov_b32 v150, 69632
    ds_read_b32 v148, v150
    s_waitcnt lgkmcnt(0)
    s_nop 0
    v_readfirstlane_b32 s26, v148
    s_nop 3
    s_cmp_lg_u32 s26, 3
    s_cbranch_scc1 L_done
    s_mov_b32 s32, s20
    s_and_b32 s33, s21, 0xffff
    s_mov_b32 s34, 16384
    s_mov_b32 s35, 0x00020000
    s_mov_b32 s36, s16
    s_and_b32 s37, s17, 0xffff
    s_mov_b32 s38, 16384
    s_mov_b32 s39, 0x00020000
    s_mov_b32 s56, 0
    s_mov_b32 s57, 32768
    s_mov_b32 s58, 65536
    s_mov_b32 s59, 98304
    s_lshl_b32 s26, s3, 17
    s_lshl_b32 s27, s6, 10
    s_add_u32 s26, s26, s27
    v_add_u32 v148, 0, v146
    v_add_u32 v148, s26, v148
    v_add_u32 v149, 8192, v146
    v_add_u32 v149, s26, v149
    v_add_u32 v150, 16384, v146
    v_add_u32 v150, s26, v150
    v_add_u32 v151, 24576, v146
    v_add_u32 v151, s26, v151
    v_lshlrev_b32 v152, 4, v144
    s_lshl_b32 s26, s3, 8
    s_lshl_b32 s27, s6, 1
    s_add_u32 s26, s26, s27
    v_add_u32 v152, s26, v152
    buffer_load_dwordx4 v[0:3], v148, s[44:47], s56 offen sc1
    buffer_load_dwordx4 v[4:7], v149, s[44:47], s56 offen sc1
    buffer_load_dwordx4 v[8:11], v150, s[44:47], s56 offen sc1
    buffer_load_dwordx4 v[12:15], v151, s[44:47], s56 offen sc1
    buffer_load_dwordx4 v[16:19], v148, s[44:47], s57 offen sc1
    buffer_load_dwordx4 v[20:23], v149, s[44:47], s57 offen sc1
    buffer_load_dwordx4 v[24:27], v150, s[44:47], s57 offen sc1
    buffer_load_dwordx4 v[28:31], v151, s[44:47], s57 offen sc1
    buffer_load_ushort v64, v152, s[36:39], 0 offen
    s_barrier
    buffer_load_dwordx4 v[32:35], v148, s[44:47], s58 offen sc1
    buffer_load_dwordx4 v[36:39], v149, s[44:47], s58 offen sc1
    buffer_load_dwordx4 v[40:43], v150, s[44:47], s58 offen sc1
    buffer_load_dwordx4 v[44:47], v151, s[44:47], s58 offen sc1
    buffer_load_dwordx4 v[48:51], v148, s[44:47], s59 offen sc1
    buffer_load_dwordx4 v[52:55], v149, s[44:47], s59 offen sc1
    buffer_load_dwordx4 v[56:59], v150, s[44:47], s59 offen sc1
    buffer_load_dwordx4 v[60:63], v151, s[44:47], s59 offen sc1
    s_waitcnt vmcnt(8)
    v_lshlrev_b32 v64, 16, v64
    v_add_f32 v0, v0, v16
    v_add_f32 v1, v1, v17
    v_add_f32 v2, v2, v18
    v_add_f32 v3, v3, v19
    v_add_f32 v4, v4, v20
    v_add_f32 v5, v5, v21
    v_add_f32 v6, v6, v22
    v_add_f32 v7, v7, v23
    v_add_f32 v8, v8, v24
    v_add_f32 v9, v9, v25
    v_add_f32 v10, v10, v26
    v_add_f32 v11, v11, v27
    v_add_f32 v12, v12, v28
    v_add_f32 v13, v13, v29
    v_add_f32 v14, v14, v30
    v_add_f32 v15, v15, v31
    v_cvt_pk_bf16_f32 v16, v0, v1
    v_cvt_pk_bf16_f32 v18, v2, v3
    v_cvt_pk_bf16_f32 v20, v4, v5
    v_cvt_pk_bf16_f32 v22, v6, v7
    v_cvt_pk_bf16_f32 v24, v8, v9
    v_cvt_pk_bf16_f32 v26, v10, v11
    v_cvt_pk_bf16_f32 v28, v12, v13
    v_cvt_pk_bf16_f32 v30, v14, v15
    v_lshlrev_b32 v0, 16, v16
    v_and_b32 v1, 0xffff0000, v16
    v_lshlrev_b32 v2, 16, v18
    v_and_b32 v3, 0xffff0000, v18
    v_lshlrev_b32 v4, 16, v20
    v_and_b32 v5, 0xffff0000, v20
    v_lshlrev_b32 v6, 16, v22
    v_and_b32 v7, 0xffff0000, v22
    v_lshlrev_b32 v8, 16, v24
    v_and_b32 v9, 0xffff0000, v24
    v_lshlrev_b32 v10, 16, v26
    v_and_b32 v11, 0xffff0000, v26
    v_lshlrev_b32 v12, 16, v28
    v_and_b32 v13, 0xffff0000, v28
    v_lshlrev_b32 v14, 16, v30
    v_and_b32 v15, 0xffff0000, v30
    v_mul_f32 v0, v0, v64
    v_mul_f32 v1, v1, v64
    v_mul_f32 v2, v2, v64
    v_mul_f32 v3, v3, v64
    v_mul_f32 v4, v4, v64
    v_mul_f32 v5, v5, v64
    v_mul_f32 v6, v6, v64
    v_mul_f32 v7, v7, v64
    v_mul_f32 v8, v8, v64
    v_mul_f32 v9, v9, v64
    v_mul_f32 v10, v10, v64
    v_mul_f32 v11, v11, v64
    v_mul_f32 v12, v12, v64
    v_mul_f32 v13, v13, v64
    v_mul_f32 v14, v14, v64
    v_mul_f32 v15, v15, v64
    v_add_f32_dpp v0, v0, v0 row_ror:8 row_mask:0xf bank_mask:0xf
    v_add_f32_dpp v1, v1, v1 row_ror:8 row_mask:0xf bank_mask:0xf
    v_add_f32_dpp v2, v2, v2 row_ror:8 row_mask:0xf bank_mask:0xf
    v_add_f32_dpp v3, v3, v3 row_ror:8 row_mask:0xf bank_mask:0xf
    v_add_f32_dpp v4, v4, v4 row_ror:8 row_mask:0xf bank_mask:0xf
    v_add_f32_dpp v5, v5, v5 row_ror:8 row_mask:0xf bank_mask:0xf
    v_add_f32_dpp v6, v6, v6 row_ror:8 row_mask:0xf bank_mask:0xf
    v_add_f32_dpp v7, v7, v7 row_ror:8 row_mask:0xf bank_mask:0xf
    v_add_f32_dpp v8, v8, v8 row_ror:8 row_mask:0xf bank_mask:0xf
    v_add_f32_dpp v9, v9, v9 row_ror:8 row_mask:0xf bank_mask:0xf
    v_add_f32_dpp v10, v10, v10 row_ror:8 row_mask:0xf bank_mask:0xf
    v_add_f32_dpp v11, v11, v11 row_ror:8 row_mask:0xf bank_mask:0xf
    v_add_f32_dpp v12, v12, v12 row_ror:8 row_mask:0xf bank_mask:0xf
    v_add_f32_dpp v13, v13, v13 row_ror:8 row_mask:0xf bank_mask:0xf
    v_add_f32_dpp v14, v14, v14 row_ror:8 row_mask:0xf bank_mask:0xf
    v_add_f32_dpp v15, v15, v15 row_ror:8 row_mask:0xf bank_mask:0xf
    v_add_f32_dpp v0, v0, v0 row_ror:4 row_mask:0xf bank_mask:0xf
    v_add_f32_dpp v1, v1, v1 row_ror:4 row_mask:0xf bank_mask:0xf
    v_add_f32_dpp v2, v2, v2 row_ror:4 row_mask:0xf bank_mask:0xf
    v_add_f32_dpp v3, v3, v3 row_ror:4 row_mask:0xf bank_mask:0xf
    v_add_f32_dpp v4, v4, v4 row_ror:4 row_mask:0xf bank_mask:0xf
    v_add_f32_dpp v5, v5, v5 row_ror:4 row_mask:0xf bank_mask:0xf
    v_add_f32_dpp v6, v6, v6 row_ror:4 row_mask:0xf bank_mask:0xf
    v_add_f32_dpp v7, v7, v7 row_ror:4 row_mask:0xf bank_mask:0xf
    v_add_f32_dpp v8, v8, v8 row_ror:4 row_mask:0xf bank_mask:0xf
    v_add_f32_dpp v9, v9, v9 row_ror:4 row_mask:0xf bank_mask:0xf
    v_add_f32_dpp v10, v10, v10 row_ror:4 row_mask:0xf bank_mask:0xf
    v_add_f32_dpp v11, v11, v11 row_ror:4 row_mask:0xf bank_mask:0xf
    v_add_f32_dpp v12, v12, v12 row_ror:4 row_mask:0xf bank_mask:0xf
    v_add_f32_dpp v13, v13, v13 row_ror:4 row_mask:0xf bank_mask:0xf
    v_add_f32_dpp v14, v14, v14 row_ror:4 row_mask:0xf bank_mask:0xf
    v_add_f32_dpp v15, v15, v15 row_ror:4 row_mask:0xf bank_mask:0xf
    v_add_f32_dpp v0, v0, v0 row_ror:2 row_mask:0xf bank_mask:0xf
    v_add_f32_dpp v1, v1, v1 row_ror:2 row_mask:0xf bank_mask:0xf
    v_add_f32_dpp v2, v2, v2 row_ror:2 row_mask:0xf bank_mask:0xf
    v_add_f32_dpp v3, v3, v3 row_ror:2 row_mask:0xf bank_mask:0xf
    v_add_f32_dpp v4, v4, v4 row_ror:2 row_mask:0xf bank_mask:0xf
    v_add_f32_dpp v5, v5, v5 row_ror:2 row_mask:0xf bank_mask:0xf
    v_add_f32_dpp v6, v6, v6 row_ror:2 row_mask:0xf bank_mask:0xf
    v_add_f32_dpp v7, v7, v7 row_ror:2 row_mask:0xf bank_mask:0xf
    v_add_f32_dpp v8, v8, v8 row_ror:2 row_mask:0xf bank_mask:0xf
    v_add_f32_dpp v9, v9, v9 row_ror:2 row_mask:0xf bank_mask:0xf
    v_add_f32_dpp v10, v10, v10 row_ror:2 row_mask:0xf bank_mask:0xf
    v_add_f32_dpp v11, v11, v11 row_ror:2 row_mask:0xf bank_mask:0xf
    v_add_f32_dpp v12, v12, v12 row_ror:2 row_mask:0xf bank_mask:0xf
    v_add_f32_dpp v13, v13, v13 row_ror:2 row_mask:0xf bank_mask:0xf
    v_add_f32_dpp v14, v14, v14 row_ror:2 row_mask:0xf bank_mask:0xf
    v_add_f32_dpp v15, v15, v15 row_ror:2 row_mask:0xf bank_mask:0xf
    v_add_f32_dpp v0, v0, v0 row_ror:1 row_mask:0xf bank_mask:0xf
    v_add_f32_dpp v1, v1, v1 row_ror:1 row_mask:0xf bank_mask:0xf
    v_add_f32_dpp v2, v2, v2 row_ror:1 row_mask:0xf bank_mask:0xf
    v_add_f32_dpp v3, v3, v3 row_ror:1 row_mask:0xf bank_mask:0xf
    v_add_f32_dpp v4, v4, v4 row_ror:1 row_mask:0xf bank_mask:0xf
    v_add_f32_dpp v5, v5, v5 row_ror:1 row_mask:0xf bank_mask:0xf
    v_add_f32_dpp v6, v6, v6 row_ror:1 row_mask:0xf bank_mask:0xf
    v_add_f32_dpp v7, v7, v7 row_ror:1 row_mask:0xf bank_mask:0xf
    v_add_f32_dpp v8, v8, v8 row_ror:1 row_mask:0xf bank_mask:0xf
    v_add_f32_dpp v9, v9, v9 row_ror:1 row_mask:0xf bank_mask:0xf
    v_add_f32_dpp v10, v10, v10 row_ror:1 row_mask:0xf bank_mask:0xf
    v_add_f32_dpp v11, v11, v11 row_ror:1 row_mask:0xf bank_mask:0xf
    v_add_f32_dpp v12, v12, v12 row_ror:1 row_mask:0xf bank_mask:0xf
    v_add_f32_dpp v13, v13, v13 row_ror:1 row_mask:0xf bank_mask:0xf
    v_add_f32_dpp v14, v14, v14 row_ror:1 row_mask:0xf bank_mask:0xf
    v_add_f32_dpp v15, v15, v15 row_ror:1 row_mask:0xf bank_mask:0xf
    s_lshl_b32 s26, s6, 8
    s_add_u32 s26, s26, 65536
    v_lshlrev_b32 v154, 4, v145
    v_add_u32 v154, s26, v154
    v_cmp_eq_u32 s[40:41], 0, v144
    s_nop 3
    s_mov_b64 exec, s[40:41]
    ds_write_b128 v154, v[0:3] offset:0
    ds_write_b128 v154, v[4:7] offset:64
    ds_write_b128 v154, v[8:11] offset:128
    ds_write_b128 v154, v[12:15] offset:192
    s_mov_b64 exec, -1
    s_waitcnt lgkmcnt(0)
    s_barrier
    v_lshlrev_b32 v155, 2, v143
    v_add_u32 v155, 65536, v155
    ds_read_b32 v66, v155 offset:0
    ds_read_b32 v67, v155 offset:256
    ds_read_b32 v68, v155 offset:512
    ds_read_b32 v69, v155 offset:768
    ds_read_b32 v70, v155 offset:1024
    ds_read_b32 v71, v155 offset:1280
    ds_read_b32 v72, v155 offset:1536
    ds_read_b32 v73, v155 offset:1792
    s_waitcnt vmcnt(0)
    v_add_f32 v32, v32, v48
    v_add_f32 v33, v33, v49
    v_add_f32 v34, v34, v50
    v_add_f32 v35, v35, v51
    v_add_f32 v36, v36, v52
    v_add_f32 v37, v37, v53
    v_add_f32 v38, v38, v54
    v_add_f32 v39, v39, v55
    v_add_f32 v40, v40, v56
    v_add_f32 v41, v41, v57
    v_add_f32 v42, v42, v58
    v_add_f32 v43, v43, v59
    v_add_f32 v44, v44, v60
    v_add_f32 v45, v45, v61
    v_add_f32 v46, v46, v62
    v_add_f32 v47, v47, v63
    v_cvt_pk_bf16_f32 v48, v32, v33
    v_cvt_pk_bf16_f32 v50, v34, v35
    v_cvt_pk_bf16_f32 v52, v36, v37
    v_cvt_pk_bf16_f32 v54, v38, v39
    v_cvt_pk_bf16_f32 v56, v40, v41
    v_cvt_pk_bf16_f32 v58, v42, v43
    v_cvt_pk_bf16_f32 v60, v44, v45
    v_cvt_pk_bf16_f32 v62, v46, v47
    v_lshlrev_b32 v32, 16, v48
    v_and_b32 v33, 0xffff0000, v48
    v_lshlrev_b32 v34, 16, v50
    v_and_b32 v35, 0xffff0000, v50
    v_lshlrev_b32 v36, 16, v52
    v_and_b32 v37, 0xffff0000, v52
    v_lshlrev_b32 v38, 16, v54
    v_and_b32 v39, 0xffff0000, v54
    v_lshlrev_b32 v40, 16, v56
    v_and_b32 v41, 0xffff0000, v56
    v_lshlrev_b32 v42, 16, v58
    v_and_b32 v43, 0xffff0000, v58
    v_lshlrev_b32 v44, 16, v60
    v_and_b32 v45, 0xffff0000, v60
    v_lshlrev_b32 v46, 16, v62
    v_and_b32 v47, 0xffff0000, v62
    s_waitcnt lgkmcnt(0)
    v_add_f32 v66, v66, v67
    v_add_f32 v66, v66, v68
    v_add_f32 v66, v66, v69
    v_add_f32 v66, v66, v70
    v_add_f32 v66, v66, v71
    v_add_f32 v66, v66, v72
    v_add_f32 v66, v66, v73
    v_bfe_u32 v153, v66, 16, 1
    v_add_u32 v153, 0x7fff, v153
    v_add_u32 v66, v66, v153
    v_and_b32 v66, 0xffff0000, v66
    v_mul_f32 v66, 0x3db504f3, v66
    v_bfe_u32 v153, v66, 16, 1
    v_add_u32 v153, 0x7fff, v153
    v_add_u32 v66, v66, v153
    v_and_b32 v66, 0xffff0000, v66
    v_mov_b32 v67, v66
    s_nop 1
    v_max_f32_dpp v67, v67, v67 row_ror:8 row_mask:0xf bank_mask:0xf
    s_nop 1
    v_max_f32_dpp v67, v67, v67 row_ror:4 row_mask:0xf bank_mask:0xf
    s_nop 1
    v_max_f32_dpp v67, v67, v67 row_ror:2 row_mask:0xf bank_mask:0xf
    s_nop 1
    v_max_f32_dpp v67, v67, v67 row_ror:1 row_mask:0xf bank_mask:0xf
    s_nop 0
    v_readlane_b32 s42, v67, 0
    v_readlane_b32 s43, v67, 16
    v_readlane_b32 s48, v67, 32
    v_readlane_b32 s49, v67, 48
    s_nop 1
    v_mov_b32 v67, s42
    v_max_f32 v67, s43, v67
    v_max_f32 v67, s48, v67
    v_max_f32 v67, s49, v67
    v_sub_f32 v66, v66, v67
    v_mul_f32 v66, 0x3fb8aa3b, v66
    v_exp_f32 v66, v66
    s_nop 1
    v_mov_b32 v67, v66
    s_nop 1
    v_add_f32_dpp v67, v67, v67 row_ror:8 row_mask:0xf bank_mask:0xf
    s_nop 1
    v_add_f32_dpp v67, v67, v67 row_ror:4 row_mask:0xf bank_mask:0xf
    s_nop 1
    v_add_f32_dpp v67, v67, v67 row_ror:2 row_mask:0xf bank_mask:0xf
    s_nop 1
    v_add_f32_dpp v67, v67, v67 row_ror:1 row_mask:0xf bank_mask:0xf
    s_nop 0
    v_readlane_b32 s42, v67, 0
    v_readlane_b32 s43, v67, 16
    v_readlane_b32 s48, v67, 32
    v_readlane_b32 s49, v67, 48
    s_nop 1
    v_mov_b32 v67, s42
    v_add_f32 v67, s43, v67
    v_add_f32 v67, s48, v67
    v_add_f32 v67, s49, v67
    v_rcp_f32 v67, v67
    s_nop 1
    v_mul_f32 v66, v66, v67
    v_bfe_u32 v153, v66, 16, 1
    v_add_u32 v153, 0x7fff, v153
    v_add_u32 v66, v66, v153
    v_and_b32 v66, 0xffff0000, v66
    s_lshl_b32 s26, s6, 8
    s_add_u32 s26, s26, 67584
    v_lshlrev_b32 v155, 2, v143
    v_add_u32 v155, s26, v155
    ds_write_b32 v155, v66
    v_lshlrev_b32 v154, 4, v145
    v_add_u32 v154, s26, v154
    s_waitcnt lgkmcnt(0)
    ds_read_b128 v[16:19], v154 offset:0
    ds_read_b128 v[20:23], v154 offset:64
    ds_read_b128 v[24:27], v154 offset:128
    ds_read_b128 v[28:31], v154 offset:192
    v_xor_b32 v148, 16, v143
    v_lshlrev_b32 v148, 2, v148
    v_xor_b32 v149, 32, v143
    v_lshlrev_b32 v149, 2, v149
    s_waitcnt lgkmcnt(0)
    v_mul_f32 v66, v16, v32
    v_fmac_f32 v66, v17, v33
    v_fmac_f32 v66, v18, v34
    v_fmac_f32 v66, v19, v35
    v_fmac_f32 v66, v20, v36
    v_fmac_f32 v66, v21, v37
    v_fmac_f32 v66, v22, v38
    v_fmac_f32 v66, v23, v39
    v_fmac_f32 v66, v24, v40
    v_fmac_f32 v66, v25, v41
    v_fmac_f32 v66, v26, v42
    v_fmac_f32 v66, v27, v43
    v_fmac_f32 v66, v28, v44
    v_fmac_f32 v66, v29, v45
    v_fmac_f32 v66, v30, v46
    v_fmac_f32 v66, v31, v47
    ds_bpermute_b32 v67, v148, v66
    s_waitcnt lgkmcnt(0)
    v_add_f32 v66, v66, v67
    ds_bpermute_b32 v67, v149, v66
    s_waitcnt lgkmcnt(0)
    v_add_f32 v66, v66, v67
    v_bfe_u32 v153, v66, 16, 1
    v_add_u32 v153, 0x7fff, v153
    v_add_u32 v66, v66, v153
    v_and_b32 v66, 0xffff0000, v66
    v_lshrrev_b32 v66, 16, v66
    v_cmp_eq_u32 s[40:41], 0, v145
    s_nop 3
    s_mov_b64 exec, s[40:41]
    buffer_store_short v66, v152, s[32:35], 0 offen
    s_waitcnt vmcnt(0)
    s_mov_b64 exec, -1
L_done:
L_exit:
    s_endpgm
.section .rodata,"a"
.p2align 6
.amdhsa_kernel standalone__low_rank_proj_linformer__decode_kernel
  .amdhsa_next_free_vgpr 256
  .amdhsa_next_free_sgpr 96
  .amdhsa_accum_offset 256
  .amdhsa_group_segment_fixed_size 0
  .amdhsa_kernarg_size 64
  .amdhsa_user_sgpr_count 2
  .amdhsa_user_sgpr_kernarg_segment_ptr 1
  .amdhsa_system_sgpr_workgroup_id_x 1
.end_amdhsa_kernel
```
